```python
import torch

def _softmax(x, axis=-1):
    return torch.softmax(x, dim=axis)
def _gelu(x):
    return torch.nn.functional.gelu(x, approximate="tanh")
def _silu(x):
    return torch.nn.functional.silu(x)
def _sigmoid(x):
    return torch.sigmoid(x)
def _layernorm(x, axis=-1, eps=1e-5):
    m = x.mean(dim=axis, keepdim=True)
    v = x.var(dim=axis, keepdim=True, unbiased=False)
    return (x - m) / torch.sqrt(v + eps)
def _scatter_add(tgt, idx, src, axis=0):
    return tgt.clone().index_add_(axis, idx, src)
def _segment_sum(src, seg, n):
    out = torch.zeros((n,) + src.shape[1:], dtype=src.dtype)
    return out.index_add_(0, seg, src)
def _pad(x, pw):
    flat = tuple(v for pair in reversed(pw) for v in pair)
    return torch.nn.functional.pad(x, flat)

kernel_name = 'interleave_layers__mha_block_cached__glu_gated_glu__decode'

def setup_inputs():

    _w = (lambda a: (lambda t: t.to(torch.bfloat16) if t.is_floating_point() else t)(torch.as_tensor(a)))
    def _A_setup():
        B, Sq, D = 2, 1, 448
        H, Sk, Dh = 16, 16384, 256
        return {
            "x": _w((lambda *s: torch.randn(*s, dtype=torch.bfloat16) * 0.05)(B, Sq, D)),
            "k_cache": _w((lambda *s: torch.randn(*s, dtype=torch.bfloat16) * 1.6)(B, H, Sk, Dh)),
            "v_cache": _w((lambda *s: torch.randn(*s, dtype=torch.bfloat16) * 1.6)(B, H, Sk, Dh)),
            "wq": _w((lambda *s: torch.randn(*s, dtype=torch.bfloat16) * 1.6)(D, H * Dh) * (D ** -0.5)),
            "wo": _w((lambda *s: torch.randn(*s, dtype=torch.bfloat16) * 1.6)(H * Dh, D) * ((H * Dh) ** -0.5)),
        }
    _A_in = _A_setup()

    def _B_setup():
        B, S, D, F = 2, 1, 448, 1792
        return {
            "x": _w((lambda *s: torch.randn(*s, dtype=torch.bfloat16) * 0.05)(B, S, D)),
            "w_gate": _w((lambda *s: torch.randn(*s, dtype=torch.bfloat16) * 0.05)(D, F)),
            "w_up": _w((lambda *s: torch.randn(*s, dtype=torch.bfloat16) * 0.05)(D, F)),
            "w_down": _w((lambda *s: torch.randn(*s, dtype=torch.bfloat16) * 0.05)(F, D)),
        }
    _B_in = _B_setup()

    return {
        "A_x": _A_in["x"],
        "A_k_cache": _A_in["k_cache"],
        "A_v_cache": _A_in["v_cache"],
        "A_wq": _A_in["wq"],
        "A_wo": _A_in["wo"],
        "B_x": _B_in["x"],
        "B_w_gate": _B_in["w_gate"],
        "B_w_up": _B_in["w_up"],
        "B_w_down": _B_in["w_down"],
    }

def reference(A_x, A_k_cache, A_v_cache, A_wq, A_wo, B_x, B_w_gate, B_w_up, B_w_down):
    def _A_ref(x, k_cache, v_cache, wq, wo):
        B, Sq, D = x.shape
        H, Dh = 16, 256
        q = (lambda x, *d: x.permute(*d))((x @ wq).reshape(B, Sq, H, Dh), 0, 2, 1, 3)
        scores = torch.einsum("bhqd,bhkd->bhqk", q, k_cache) * (Dh ** -0.5)
        p = _softmax(scores, axis=-1)
        o = torch.einsum("bhqk,bhkd->bhqd", p, v_cache)
        return (lambda x, *d: x.permute(*d))(o, 0, 2, 1, 3).reshape(B, Sq, H * Dh) @ wo

    def _B_ref(x, w_gate, w_up, w_down):
        g = torch.einsum("bsd,df->bsf", x, w_gate)
        u = torch.einsum("bsd,df->bsf", x, w_up)
        h = _sigmoid(g) * u
        return torch.einsum("bsf,fd->bsd", h, w_down)

    x = A_x
    x = x + _A_ref(_layernorm(x, axis=-1), A_k_cache, A_v_cache, A_wq, A_wo)
    x = x + _B_ref(_layernorm(x, axis=-1), B_w_gate, B_w_up, B_w_down)
    x = x + _A_ref(_layernorm(x, axis=-1), A_k_cache, A_v_cache, A_wq, A_wo)
    x = x + _B_ref(_layernorm(x, axis=-1), B_w_gate, B_w_up, B_w_down)
    return x
```

```asm
; @launch grid=(256,1,1) block=(256,1,1) lds=163840
.amdgcn_target "amdgcn-amd-amdhsa--gfx950"
.text
.globl interleave_layers__mha_block_cached__glu_gated_glu__decode_kernel
.p2align 8
.type interleave_layers__mha_block_cached__glu_gated_glu__decode_kernel,@function
interleave_layers__mha_block_cached__glu_gated_glu__decode_kernel:
    s_cmp_ge_u32 s2, 256
    s_cbranch_scc1 L_END
    s_load_dwordx16 s[16:31], s[0:1], 0
    s_load_dwordx8 s[32:39], s[0:1], 64
    s_getpc_b64 s[4:5]
    v_lshlrev_b32 v2, 6, v0
    global_load_dword v63, v2, s[4:5]
    v_add_u32 v2, 0x4000, v2
    global_load_dword v63, v2, s[4:5]
    v_add_u32 v2, 0x4000, v2
    global_load_dword v63, v2, s[4:5]
    v_add_u32 v2, 0x4000, v2
    v_lshrrev_b32 v1, 6, v0
    v_and_b32 v0, 63, v0
    v_readfirstlane_b32 s3, v1
    s_mov_b32 s96, 400000
    s_waitcnt lgkmcnt(0)
    s_mov_b32 s48, s38
    s_and_b32 s49, s39, 0xffff
    s_mov_b32 s50, 1572864
    s_mov_b32 s51, 0x20000
    s_mov_b32 s52, s36
    s_and_b32 s53, s37, 0xffff
    s_mov_b32 s54, 256
    s_mov_b32 s55, 0x20000
    s_cmp_lt_u32 s2, 16
    s_cbranch_scc1 L_SERVICE
    s_sub_u32 s15, s2, 16
    s_mul_hi_u32 s4, s15, 0x11111112
    s_mul_i32 s74, s4, 15
    s_sub_u32 s5, s15, s74
    s_lshl_b32 s6, s5, 2
    s_add_u32 s6, s6, s3
    s_lshl_b32 s7, s4, 23
    s_mov_b32 s40, s18
    s_and_b32 s41, s19, 0xffff
    s_mov_b32 s42, 268435456
    s_mov_b32 s43, 0x20000
    s_mov_b32 s44, s20
    s_and_b32 s45, s21, 0xffff
    s_mov_b32 s46, 268435456
    s_mov_b32 s47, 0x20000
    v_lshrrev_b32 v14, 3, v0
    v_and_b32 v15, 7, v0
    v_lshlrev_b32 v14, 9, v14
    v_lshl_add_u32 v1, v15, 4, v14
    v_lshrrev_b32 v14, 4, v0
    v_and_b32 v15, 15, v0
    v_lshlrev_b32 v14, 10, v14
    v_lshl_add_u32 v2, v15, 4, v14
    s_lshl_b32 s75, s6, 12
    s_add_u32 s75, s75, s7
    s_mul_i32 s78, s3, 36864
    s_add_u32 s74, s75, 0
    s_waitcnt vmcnt(12)
    buffer_load_dwordx4 v[128:131], v1, s[40:43], s74 offen offset:0 nt
    buffer_load_dwordx4 v[132:135], v1, s[40:43], s74 offen offset:128 nt
    buffer_load_dwordx4 v[136:139], v1, s[40:43], s74 offen offset:256 nt
    buffer_load_dwordx4 v[140:143], v1, s[40:43], s74 offen offset:384 nt
    s_add_u32 s74, s75, 245760
    s_waitcnt vmcnt(12)
    buffer_load_dwordx4 v[144:147], v1, s[40:43], s74 offen offset:0 nt
    buffer_load_dwordx4 v[148:151], v1, s[40:43], s74 offen offset:128 nt
    buffer_load_dwordx4 v[152:155], v1, s[40:43], s74 offen offset:256 nt
    buffer_load_dwordx4 v[156:159], v1, s[40:43], s74 offen offset:384 nt
    s_add_u32 s74, s75, 0
    s_waitcnt vmcnt(12)
    buffer_load_dwordx4 a[0:3], v2, s[44:47], s74 offen offset:0 nt
    buffer_load_dwordx4 a[4:7], v2, s[44:47], s74 offen offset:256 nt
    buffer_load_dwordx4 a[8:11], v2, s[44:47], s74 offen offset:512 nt
    buffer_load_dwordx4 a[12:15], v2, s[44:47], s74 offen offset:768 nt
    s_add_u32 s74, s75, 245760
    s_waitcnt vmcnt(12)
    buffer_load_dwordx4 a[16:19], v2, s[44:47], s74 offen offset:0 nt
    buffer_load_dwordx4 a[20:23], v2, s[44:47], s74 offen offset:256 nt
    buffer_load_dwordx4 a[24:27], v2, s[44:47], s74 offen offset:512 nt
    buffer_load_dwordx4 a[28:31], v2, s[44:47], s74 offen offset:768 nt
    s_add_u32 s74, s75, 491520
    s_waitcnt vmcnt(12)
    buffer_load_dwordx4 v[160:163], v1, s[40:43], s74 offen offset:0 nt
    buffer_load_dwordx4 v[164:167], v1, s[40:43], s74 offen offset:128 nt
    buffer_load_dwordx4 v[168:171], v1, s[40:43], s74 offen offset:256 nt
    buffer_load_dwordx4 v[172:175], v1, s[40:43], s74 offen offset:384 nt
    s_add_u32 s74, s75, 737280
    s_waitcnt vmcnt(12)
    buffer_load_dwordx4 v[176:179], v1, s[40:43], s74 offen offset:0 nt
    buffer_load_dwordx4 v[180:183], v1, s[40:43], s74 offen offset:128 nt
    buffer_load_dwordx4 v[184:187], v1, s[40:43], s74 offen offset:256 nt
    buffer_load_dwordx4 v[188:191], v1, s[40:43], s74 offen offset:384 nt
    s_add_u32 s74, s75, 491520
    s_waitcnt vmcnt(12)
    buffer_load_dwordx4 a[32:35], v2, s[44:47], s74 offen offset:0 nt
    buffer_load_dwordx4 a[36:39], v2, s[44:47], s74 offen offset:256 nt
    buffer_load_dwordx4 a[40:43], v2, s[44:47], s74 offen offset:512 nt
    buffer_load_dwordx4 a[44:47], v2, s[44:47], s74 offen offset:768 nt
    s_add_u32 s74, s75, 737280
    s_waitcnt vmcnt(12)
    buffer_load_dwordx4 a[48:51], v2, s[44:47], s74 offen offset:0 nt
    buffer_load_dwordx4 a[52:55], v2, s[44:47], s74 offen offset:256 nt
    buffer_load_dwordx4 a[56:59], v2, s[44:47], s74 offen offset:512 nt
    buffer_load_dwordx4 a[60:63], v2, s[44:47], s74 offen offset:768 nt
    s_add_u32 s74, s75, 983040
    s_waitcnt vmcnt(12)
    buffer_load_dwordx4 v[192:195], v1, s[40:43], s74 offen offset:0 nt
    buffer_load_dwordx4 v[196:199], v1, s[40:43], s74 offen offset:128 nt
    buffer_load_dwordx4 v[200:203], v1, s[40:43], s74 offen offset:256 nt
    buffer_load_dwordx4 v[204:207], v1, s[40:43], s74 offen offset:384 nt
    s_add_u32 s74, s75, 1228800
    s_waitcnt vmcnt(12)
    buffer_load_dwordx4 v[208:211], v1, s[40:43], s74 offen offset:0 nt
    buffer_load_dwordx4 v[212:215], v1, s[40:43], s74 offen offset:128 nt
    buffer_load_dwordx4 v[216:219], v1, s[40:43], s74 offen offset:256 nt
    buffer_load_dwordx4 v[220:223], v1, s[40:43], s74 offen offset:384 nt
    s_add_u32 s74, s75, 983040
    s_waitcnt vmcnt(12)
    buffer_load_dwordx4 a[64:67], v2, s[44:47], s74 offen offset:0 nt
    buffer_load_dwordx4 a[68:71], v2, s[44:47], s74 offen offset:256 nt
    buffer_load_dwordx4 a[72:75], v2, s[44:47], s74 offen offset:512 nt
    buffer_load_dwordx4 a[76:79], v2, s[44:47], s74 offen offset:768 nt
    s_add_u32 s74, s75, 1228800
    s_waitcnt vmcnt(12)
    buffer_load_dwordx4 a[80:83], v2, s[44:47], s74 offen offset:0 nt
    buffer_load_dwordx4 a[84:87], v2, s[44:47], s74 offen offset:256 nt
    buffer_load_dwordx4 a[88:91], v2, s[44:47], s74 offen offset:512 nt
    buffer_load_dwordx4 a[92:95], v2, s[44:47], s74 offen offset:768 nt
    s_add_u32 s74, s75, 1474560
    s_waitcnt vmcnt(12)
    buffer_load_dwordx4 v[224:227], v1, s[40:43], s74 offen offset:0 nt
    buffer_load_dwordx4 v[228:231], v1, s[40:43], s74 offen offset:128 nt
    buffer_load_dwordx4 v[232:235], v1, s[40:43], s74 offen offset:256 nt
    buffer_load_dwordx4 v[236:239], v1, s[40:43], s74 offen offset:384 nt
    s_add_u32 s74, s75, 1720320
    s_waitcnt vmcnt(12)
    buffer_load_dwordx4 v[240:243], v1, s[40:43], s74 offen offset:0 nt
    buffer_load_dwordx4 v[244:247], v1, s[40:43], s74 offen offset:128 nt
    buffer_load_dwordx4 v[248:251], v1, s[40:43], s74 offen offset:256 nt
    buffer_load_dwordx4 v[252:255], v1, s[40:43], s74 offen offset:384 nt
    s_add_u32 s74, s75, 1474560
    s_waitcnt vmcnt(12)
    buffer_load_dwordx4 a[96:99], v2, s[44:47], s74 offen offset:0 nt
    buffer_load_dwordx4 a[100:103], v2, s[44:47], s74 offen offset:256 nt
    buffer_load_dwordx4 a[104:107], v2, s[44:47], s74 offen offset:512 nt
    buffer_load_dwordx4 a[108:111], v2, s[44:47], s74 offen offset:768 nt
    s_add_u32 s74, s75, 1720320
    s_waitcnt vmcnt(12)
    buffer_load_dwordx4 a[112:115], v2, s[44:47], s74 offen offset:0 nt
    buffer_load_dwordx4 a[116:119], v2, s[44:47], s74 offen offset:256 nt
    buffer_load_dwordx4 a[120:123], v2, s[44:47], s74 offen offset:512 nt
    buffer_load_dwordx4 a[124:127], v2, s[44:47], s74 offen offset:768 nt
    s_mov_b32 s72, 0x3db8aa3b
    s_mul_i32 s73, s4, 98304
    v_mov_b32 v3, 1
    v_mov_b32 v12, 1
    v_and_b32 v14, 15, v0
    v_and_b32 v15, 1, v0
    v_lshlrev_b32 v15, 4, v15
    v_mov_b32 v4, 0xffff
    v_lshlrev_b32 v15, v15, v4
    v_lshrrev_b32 v14, 1, v14
    v_cmp_eq_u32 vcc, 0, v14
    s_nop 1
    v_cndmask_b32 v4, 0, v15, vcc
    v_cmp_eq_u32 vcc, 1, v14
    s_nop 1
    v_cndmask_b32 v5, 0, v15, vcc
    v_cmp_eq_u32 vcc, 2, v14
    s_nop 1
    v_cndmask_b32 v6, 0, v15, vcc
    v_cmp_eq_u32 vcc, 3, v14
    s_nop 1
    v_cndmask_b32 v7, 0, v15, vcc
    v_lshlrev_b32 v14, 2, v0
    v_and_b32 v14, 12, v14
    v_add_u32 v14, 155904, v14
    v_mov_b32 v15, 0
    ds_write_b32 v14, v15
    s_waitcnt lgkmcnt(0)
    s_barrier
    s_lshl_b32 s15, s4, 2
    buffer_load_dword v13, off, s[52:55], s15 offset:128 sc1
    s_add_u32 s74, s75, 1966080
    s_waitcnt vmcnt(12)
    s_add_u32 m0, s78, 0
    s_nop 0
    buffer_load_dwordx4 v1, s[40:43], s74 offen offset:0 nt lds
    s_add_u32 m0, s78, 896
    s_nop 0
    buffer_load_dwordx4 v1, s[40:43], s74 offen offset:128 nt lds
    s_add_u32 m0, s78, 1792
    s_nop 0
    buffer_load_dwordx4 v1, s[40:43], s74 offen offset:256 nt lds
    s_add_u32 m0, s78, 2688
    s_nop 0
    buffer_load_dwordx4 v1, s[40:43], s74 offen offset:384 nt lds
    s_add_u32 s74, s75, 2211840
    s_waitcnt vmcnt(12)
    s_add_u32 m0, s78, 4096
    s_nop 0
    buffer_load_dwordx4 v1, s[40:43], s74 offen offset:0 nt lds
    s_add_u32 m0, s78, 4992
    s_nop 0
    buffer_load_dwordx4 v1, s[40:43], s74 offen offset:128 nt lds
    s_add_u32 m0, s78, 5888
    s_nop 0
    buffer_load_dwordx4 v1, s[40:43], s74 offen offset:256 nt lds
    s_add_u32 m0, s78, 6784
    s_nop 0
    buffer_load_dwordx4 v1, s[40:43], s74 offen offset:384 nt lds
    s_add_u32 s74, s75, 1966080
    s_waitcnt vmcnt(12)
    buffer_load_dwordx4 a[128:131], v2, s[44:47], s74 offen offset:0 nt
    buffer_load_dwordx4 a[132:135], v2, s[44:47], s74 offen offset:256 nt
    buffer_load_dwordx4 a[136:139], v2, s[44:47], s74 offen offset:512 nt
    buffer_load_dwordx4 a[140:143], v2, s[44:47], s74 offen offset:768 nt
    s_add_u32 s74, s75, 2211840
    s_waitcnt vmcnt(12)
    buffer_load_dwordx4 a[144:147], v2, s[44:47], s74 offen offset:0 nt
    buffer_load_dwordx4 a[148:151], v2, s[44:47], s74 offen offset:256 nt
    buffer_load_dwordx4 a[152:155], v2, s[44:47], s74 offen offset:512 nt
    buffer_load_dwordx4 a[156:159], v2, s[44:47], s74 offen offset:768 nt
    s_add_u32 s74, s75, 2457600
    s_waitcnt vmcnt(12)
    s_add_u32 m0, s78, 8192
    s_nop 0
    buffer_load_dwordx4 v1, s[40:43], s74 offen offset:0 nt lds
    s_add_u32 m0, s78, 9088
    s_nop 0
    buffer_load_dwordx4 v1, s[40:43], s74 offen offset:128 nt lds
    s_add_u32 m0, s78, 9984
    s_nop 0
    buffer_load_dwordx4 v1, s[40:43], s74 offen offset:256 nt lds
    s_add_u32 m0, s78, 10880
    s_nop 0
    buffer_load_dwordx4 v1, s[40:43], s74 offen offset:384 nt lds
    s_add_u32 s74, s75, 2703360
    s_waitcnt vmcnt(12)
    s_add_u32 m0, s78, 12288
    s_nop 0
    buffer_load_dwordx4 v1, s[40:43], s74 offen offset:0 nt lds
    s_add_u32 m0, s78, 13184
    s_nop 0
    buffer_load_dwordx4 v1, s[40:43], s74 offen offset:128 nt lds
    s_add_u32 m0, s78, 14080
    s_nop 0
    buffer_load_dwordx4 v1, s[40:43], s74 offen offset:256 nt lds
    s_add_u32 m0, s78, 14976
    s_nop 0
    buffer_load_dwordx4 v1, s[40:43], s74 offen offset:384 nt lds
    s_add_u32 s74, s75, 2457600
    s_waitcnt vmcnt(12)
    buffer_load_dwordx4 a[160:163], v2, s[44:47], s74 offen offset:0 nt
    buffer_load_dwordx4 a[164:167], v2, s[44:47], s74 offen offset:256 nt
    buffer_load_dwordx4 a[168:171], v2, s[44:47], s74 offen offset:512 nt
    buffer_load_dwordx4 a[172:175], v2, s[44:47], s74 offen offset:768 nt
    s_add_u32 s74, s75, 2703360
    s_waitcnt vmcnt(12)
    buffer_load_dwordx4 a[176:179], v2, s[44:47], s74 offen offset:0 nt
    buffer_load_dwordx4 a[180:183], v2, s[44:47], s74 offen offset:256 nt
    buffer_load_dwordx4 a[184:187], v2, s[44:47], s74 offen offset:512 nt
    buffer_load_dwordx4 a[188:191], v2, s[44:47], s74 offen offset:768 nt
    s_add_u32 s74, s75, 2949120
    s_waitcnt vmcnt(12)
    s_add_u32 m0, s78, 16384
    s_nop 0
    buffer_load_dwordx4 v1, s[40:43], s74 offen offset:0 nt lds
    s_add_u32 m0, s78, 17280
    s_nop 0
    buffer_load_dwordx4 v1, s[40:43], s74 offen offset:128 nt lds
    s_add_u32 m0, s78, 18176
    s_nop 0
    buffer_load_dwordx4 v1, s[40:43], s74 offen offset:256 nt lds
    s_add_u32 m0, s78, 19072
    s_nop 0
    buffer_load_dwordx4 v1, s[40:43], s74 offen offset:384 nt lds
    s_add_u32 s74, s75, 3194880
    s_waitcnt vmcnt(12)
    s_add_u32 m0, s78, 20480
    s_nop 0
    buffer_load_dwordx4 v1, s[40:43], s74 offen offset:0 nt lds
    s_add_u32 m0, s78, 21376
    s_nop 0
    buffer_load_dwordx4 v1, s[40:43], s74 offen offset:128 nt lds
    s_add_u32 m0, s78, 22272
    s_nop 0
    buffer_load_dwordx4 v1, s[40:43], s74 offen offset:256 nt lds
    s_add_u32 m0, s78, 23168
    s_nop 0
    buffer_load_dwordx4 v1, s[40:43], s74 offen offset:384 nt lds
    s_add_u32 s74, s75, 2949120
    s_waitcnt vmcnt(12)
    buffer_load_dwordx4 a[192:195], v2, s[44:47], s74 offen offset:0 nt
    buffer_load_dwordx4 a[196:199], v2, s[44:47], s74 offen offset:256 nt
    buffer_load_dwordx4 a[200:203], v2, s[44:47], s74 offen offset:512 nt
    buffer_load_dwordx4 a[204:207], v2, s[44:47], s74 offen offset:768 nt
    s_add_u32 s74, s75, 3194880
    s_waitcnt vmcnt(12)
    buffer_load_dwordx4 a[208:211], v2, s[44:47], s74 offen offset:0 nt
    buffer_load_dwordx4 a[212:215], v2, s[44:47], s74 offen offset:256 nt
    buffer_load_dwordx4 a[216:219], v2, s[44:47], s74 offen offset:512 nt
    buffer_load_dwordx4 a[220:223], v2, s[44:47], s74 offen offset:768 nt
    s_add_u32 s74, s75, 3440640
    s_waitcnt vmcnt(12)
    s_add_u32 m0, s78, 24576
    s_nop 0
    buffer_load_dwordx4 v1, s[40:43], s74 offen offset:0 nt lds
    s_add_u32 m0, s78, 25472
    s_nop 0
    buffer_load_dwordx4 v1, s[40:43], s74 offen offset:128 nt lds
    s_add_u32 m0, s78, 26368
    s_nop 0
    buffer_load_dwordx4 v1, s[40:43], s74 offen offset:256 nt lds
    s_add_u32 m0, s78, 27264
    s_nop 0
    buffer_load_dwordx4 v1, s[40:43], s74 offen offset:384 nt lds
    s_add_u32 s74, s75, 3686400
    s_waitcnt vmcnt(12)
    s_add_u32 m0, s78, 28672
    s_nop 0
    buffer_load_dwordx4 v1, s[40:43], s74 offen offset:0 nt lds
    s_add_u32 m0, s78, 29568
    s_nop 0
    buffer_load_dwordx4 v1, s[40:43], s74 offen offset:128 nt lds
    s_add_u32 m0, s78, 30464
    s_nop 0
    buffer_load_dwordx4 v1, s[40:43], s74 offen offset:256 nt lds
    s_add_u32 m0, s78, 31360
    s_nop 0
    buffer_load_dwordx4 v1, s[40:43], s74 offen offset:384 nt lds
    s_add_u32 s74, s75, 3440640
    s_waitcnt vmcnt(12)
    buffer_load_dwordx4 a[224:227], v2, s[44:47], s74 offen offset:0 nt
    buffer_load_dwordx4 a[228:231], v2, s[44:47], s74 offen offset:256 nt
    buffer_load_dwordx4 a[232:235], v2, s[44:47], s74 offen offset:512 nt
    buffer_load_dwordx4 a[236:239], v2, s[44:47], s74 offen offset:768 nt
    s_add_u32 s74, s75, 3686400
    s_waitcnt vmcnt(12)
    buffer_load_dwordx4 a[240:243], v2, s[44:47], s74 offen offset:0 nt
    buffer_load_dwordx4 a[244:247], v2, s[44:47], s74 offen offset:256 nt
    buffer_load_dwordx4 a[248:251], v2, s[44:47], s74 offen offset:512 nt
    buffer_load_dwordx4 a[252:255], v2, s[44:47], s74 offen offset:768 nt
L_FLAGCHK:
    v_readfirstlane_b32 s74, v13
    s_nop 1
    s_cmp_lg_u32 s74, 0
    s_cbranch_scc1 L_FLAGOK
    s_sleep 2
    s_sub_u32 s96, s96, 1
    s_cmp_eq_u32 s96, 0
    s_cbranch_scc1 L_END
    buffer_load_dword v13, off, s[52:55], s15 offset:128 sc1
    s_waitcnt vmcnt(0)
    s_branch L_FLAGCHK
L_FLAGOK:
    s_mov_b64 exec, 1
    buffer_atomic_add v12, off, s[48:51], s73 sc0 sc1
    s_mov_b64 exec, -1
    s_mov_b64 exec, 1
    buffer_atomic_add v3, off, s[48:51], s73 sc0 sc1
    s_mov_b64 exec, -1
    s_mov_b32 s8, 0
    s_lshl_b32 s74, s8, 9
    s_add_u32 s74, s74, s73
    v_lshlrev_b32 v14, 3, v0
    buffer_load_dwordx2 v[10:11], v14, s[48:51], s74 offen offset:256 sc1
    s_add_u32 s74, s75, 3932160
    s_waitcnt vmcnt(12)
    s_add_u32 m0, s78, 32768
    s_nop 0
    buffer_load_dwordx4 v1, s[40:43], s74 offen offset:0 nt lds
    s_add_u32 m0, s78, 33664
    s_nop 0
    buffer_load_dwordx4 v1, s[40:43], s74 offen offset:128 nt lds
    s_add_u32 m0, s78, 34560
    s_nop 0
    buffer_load_dwordx4 v1, s[40:43], s74 offen offset:256 nt lds
    s_add_u32 m0, s78, 35456
    s_nop 0
    buffer_load_dwordx4 v1, s[40:43], s74 offen offset:384 nt lds
    s_add_u32 s74, s75, 3932160
    s_waitcnt vmcnt(12)
    buffer_load_dwordx4 v[48:51], v2, s[44:47], s74 offen offset:0 nt
    buffer_load_dwordx4 v[52:55], v2, s[44:47], s74 offen offset:256 nt
    buffer_load_dwordx4 v[56:59], v2, s[44:47], s74 offen offset:512 nt
    buffer_load_dwordx4 v[60:63], v2, s[44:47], s74 offen offset:768 nt
    s_add_u32 s75, s75, 0x08000000
    s_mov_b32 s14, 0
    s_mov_b32 s9, 514
    s_add_u32 s10, s7, 4177920
    s_mov_b32 s13, 0
    s_mov_b32 s81, 0
    s_waitcnt vmcnt(8)
    v_readfirstlane_b32 s15, v12
    v_mov_b32 v12, 1
    s_add_u32 s15, s15, 1
L_DEC0:
    s_cmp_lt_u32 s15, s9
    s_cbranch_scc1 L_DOK0
    s_add_u32 s8, s8, 1
    s_add_u32 s9, s9, 514
    s_bitcmp1_b32 s8, 0
    s_cselect_b32 s74, 0x10000000, 0
    s_add_u32 s10, s10, s74
    s_sub_u32 s10, s10, 138428416
    s_cmp_lt_u32 s8, 4
    s_cbranch_scc0 L_DFIN0
    s_lshl_b32 s74, s8, 9
    s_add_u32 s74, s74, s73
    v_lshlrev_b32 v14, 3, v0
    buffer_load_dwordx2 v[10:11], v14, s[48:51], s74 offen offset:256 sc1
    s_mov_b32 s14, s8
    s_branch L_DEC0
L_DFIN0:
    s_mov_b32 s9, -1
L_DOK0:
    s_lshl_b32 s11, s15, 13
    s_add_u32 s11, s11, s10
    s_cmp_ge_u32 s8, 4
    s_cselect_b32 s11, 0x80000000, s11
    s_add_u32 s76, s11, 4096
    s_sub_u32 s74, s15, 1028
    s_cmp_lt_u32 s74, 200
    s_cselect_b32 s80, 1, 0
    buffer_load_dwordx4 v[64:67], v1, s[40:43], s11 offen offset:0 nt
    buffer_load_dwordx4 v[68:71], v1, s[40:43], s11 offen offset:128 nt
    buffer_load_dwordx4 v[72:75], v1, s[40:43], s11 offen offset:256 nt
    buffer_load_dwordx4 v[76:79], v1, s[40:43], s11 offen offset:384 nt
    buffer_load_dwordx4 v[80:83], v1, s[40:43], s76 offen offset:0 nt
    buffer_load_dwordx4 v[84:87], v1, s[40:43], s76 offen offset:128 nt
    buffer_load_dwordx4 v[88:91], v1, s[40:43], s76 offen offset:256 nt
    buffer_load_dwordx4 v[92:95], v1, s[40:43], s76 offen offset:384 nt
    buffer_load_dwordx4 v[96:99], v2, s[44:47], s11 offen offset:0 nt
    buffer_load_dwordx4 v[100:103], v2, s[44:47], s11 offen offset:256 nt
    buffer_load_dwordx4 v[104:107], v2, s[44:47], s11 offen offset:512 nt
    buffer_load_dwordx4 v[108:111], v2, s[44:47], s11 offen offset:768 nt
    buffer_load_dwordx4 v[112:115], v2, s[44:47], s76 offen offset:0 nt
    buffer_load_dwordx4 v[116:119], v2, s[44:47], s76 offen offset:256 nt
    buffer_load_dwordx4 v[120:123], v2, s[44:47], s76 offen offset:512 nt
    buffer_load_dwordx4 v[124:127], v2, s[44:47], s76 offen offset:768 nt
    s_mov_b32 s12, s8
    s_waitcnt vmcnt(12)
    v_readfirstlane_b32 s15, v3
    v_mov_b32 v3, 1
    s_add_u32 s15, s15, 1
L_DEC1:
    s_cmp_lt_u32 s15, s9
    s_cbranch_scc1 L_DOK1
    s_add_u32 s8, s8, 1
    s_add_u32 s9, s9, 514
    s_bitcmp1_b32 s8, 0
    s_cselect_b32 s74, 0x10000000, 0
    s_add_u32 s10, s10, s74
    s_sub_u32 s10, s10, 138428416
    s_cmp_lt_u32 s8, 4
    s_cbranch_scc0 L_DFIN1
    s_lshl_b32 s74, s8, 9
    s_add_u32 s74, s74, s73
    v_lshlrev_b32 v14, 3, v0
    buffer_load_dwordx2 v[10:11], v14, s[48:51], s74 offen offset:256 sc1
    s_mov_b32 s14, s8
    s_branch L_DEC1
L_DFIN1:
    s_mov_b32 s9, -1
L_DOK1:
    s_lshl_b32 s11, s15, 13
    s_add_u32 s11, s11, s10
    s_cmp_ge_u32 s8, 4
    s_cselect_b32 s11, 0x80000000, s11
    s_add_u32 s76, s11, 4096
    s_sub_u32 s74, s15, 1028
    s_cmp_lt_u32 s74, 200
    s_cselect_b32 s80, 1, 0
    s_mov_b64 exec, 1
    buffer_atomic_add v3, off, s[48:51], s73 sc0 sc1
    s_mov_b64 exec, -1
    s_branch L_SETUP
.p2align 6
L_LOOP:
    s_waitcnt vmcnt(12)
    v_readfirstlane_b32 s15, v3
    v_mov_b32 v3, 1
    s_add_u32 s15, s15, 1
L_DEC2:
    s_cmp_lt_u32 s15, s9
    s_cbranch_scc1 L_DOK2
    s_add_u32 s8, s8, 1
    s_add_u32 s9, s9, 514
    s_bitcmp1_b32 s8, 0
    s_cselect_b32 s74, 0x10000000, 0
    s_add_u32 s10, s10, s74
    s_sub_u32 s10, s10, 138428416
    s_cmp_lt_u32 s8, 4
    s_cbranch_scc0 L_DFIN2
    s_lshl_b32 s74, s8, 9
    s_add_u32 s74, s74, s73
    v_lshlrev_b32 v14, 3, v0
    buffer_load_dwordx2 v[10:11], v14, s[48:51], s74 offen offset:256 sc1
    s_mov_b32 s14, s8
    s_branch L_DEC2
L_DFIN2:
    s_mov_b32 s9, -1
L_DOK2:
    s_lshl_b32 s11, s15, 13
    s_add_u32 s11, s11, s10
    s_cmp_ge_u32 s8, 4
    s_cselect_b32 s11, 0x80000000, s11
    s_add_u32 s76, s11, 4096
    s_sub_u32 s74, s15, 1028
    s_cmp_lt_u32 s74, 200
    s_cselect_b32 s80, 1, 0
    s_mov_b64 exec, 1
    buffer_atomic_add v3, off, s[48:51], s73 sc0 sc1
    s_mov_b64 exec, -1
    s_cmp_lg_u32 s12, s13
    s_cbranch_scc1 L_SWITCH
L_BODY:
    v_dot2_f32_bf16 v14, v64, v32, 0
    v_dot2_f32_bf16 v15, v72, v40, 0
    v_dot2_f32_bf16 v14, v65, v33, v14
    v_dot2_f32_bf16 v15, v73, v41, v15
    v_dot2_f32_bf16 v14, v66, v34, v14
    v_dot2_f32_bf16 v15, v74, v42, v15
    v_dot2_f32_bf16 v14, v67, v35, v14
    v_dot2_f32_bf16 v15, v75, v43, v15
    v_dot2_f32_bf16 v14, v68, v36, v14
    v_dot2_f32_bf16 v15, v76, v44, v15
    v_dot2_f32_bf16 v14, v69, v37, v14
    v_dot2_f32_bf16 v15, v77, v45, v15
    v_dot2_f32_bf16 v14, v70, v38, v14
    v_dot2_f32_bf16 v15, v78, v46, v15
    v_dot2_f32_bf16 v14, v71, v39, v14
    v_dot2_f32_bf16 v15, v79, v47, v15
    s_nop 2
    v_add_f32 v12, v14, v15
    s_cmp_eq_u32 s80, 0
    s_cbranch_scc1 L_SL0
    s_waitcnt vmcnt(4)
L_SL0:
    buffer_load_dwordx4 v[64:67], v1, s[40:43], s11 offen offset:0 nt
    buffer_load_dwordx4 v[68:71], v1, s[40:43], s11 offen offset:128 nt
    buffer_load_dwordx4 v[72:75], v1, s[40:43], s11 offen offset:256 nt
    buffer_load_dwordx4 v[76:79], v1, s[40:43], s11 offen offset:384 nt
    s_waitcnt vmcnt(13)
    v_dot2_f32_bf16 v14, v80, v32, 0
    v_dot2_f32_bf16 v15, v88, v40, 0
    v_dot2_f32_bf16 v14, v81, v33, v14
    v_dot2_f32_bf16 v15, v89, v41, v15
    v_dot2_f32_bf16 v14, v82, v34, v14
    v_dot2_f32_bf16 v15, v90, v42, v15
    v_dot2_f32_bf16 v14, v83, v35, v14
    v_dot2_f32_bf16 v15, v91, v43, v15
    v_dot2_f32_bf16 v14, v84, v36, v14
    v_dot2_f32_bf16 v15, v92, v44, v15
    v_dot2_f32_bf16 v14, v85, v37, v14
    v_dot2_f32_bf16 v15, v93, v45, v15
    v_dot2_f32_bf16 v14, v86, v38, v14
    v_dot2_f32_bf16 v15, v94, v46, v15
    v_dot2_f32_bf16 v14, v87, v39, v14
    v_dot2_f32_bf16 v15, v95, v47, v15
    s_nop 2
    v_add_f32 v13, v14, v15
    s_cmp_eq_u32 s80, 0
    s_cbranch_scc1 L_SL1
    s_waitcnt vmcnt(4)
L_SL1:
    buffer_load_dwordx4 v[80:83], v1, s[40:43], s76 offen offset:0 nt
    buffer_load_dwordx4 v[84:87], v1, s[40:43], s76 offen offset:128 nt
    buffer_load_dwordx4 v[88:91], v1, s[40:43], s76 offen offset:256 nt
    buffer_load_dwordx4 v[92:95], v1, s[40:43], s76 offen offset:384 nt
    s_nop 0
    v_add_f32_dpp v12, v12, v12 quad_perm:[1,0,3,2] row_mask:0xf bank_mask:0xf
    v_add_f32_dpp v13, v13, v13 quad_perm:[1,0,3,2] row_mask:0xf bank_mask:0xf
    s_nop 0
    s_nop 0
    v_add_f32_dpp v12, v12, v12 quad_perm:[2,3,0,1] row_mask:0xf bank_mask:0xf
    v_add_f32_dpp v13, v13, v13 quad_perm:[2,3,0,1] row_mask:0xf bank_mask:0xf
    s_nop 0
    s_nop 0
    v_add_f32_dpp v12, v12, v12 row_half_mirror row_mask:0xf bank_mask:0xf
    v_add_f32_dpp v13, v13, v13 row_half_mirror row_mask:0xf bank_mask:0xf
    s_nop 0
    v_cvt_pk_bf16_f32 v15, v12, v13
    v_lshlrev_b32 v12, 16, v15
    v_and_b32 v13, 0xffff0000, v15
    v_max_f32 v14, v12, v13
    s_nop 1
    v_max_f32_dpp v14, v14, v14 row_ror:8 row_mask:0xf bank_mask:0xf
    v_mov_b32 v15, v14
    s_nop 1
    v_permlane16_swap_b32 v14, v15
    s_nop 0
    v_max_f32 v14, v14, v15
    v_mov_b32 v15, v14
    s_nop 1
    v_permlane32_swap_b32 v14, v15
    s_nop 0
    v_max_f32 v14, v14, v15
    v_mul_f32 v14, s72, v14
    v_ceil_f32 v14, v14
    v_max_f32 v14, v14, v8
    v_sub_f32 v15, v8, v14
    v_fma_f32 v12, v12, s72, -v14
    v_fma_f32 v13, v13, s72, -v14
    v_exp_f32 v15, v15
    v_exp_f32 v12, v12
    v_exp_f32 v13, v13
    v_mov_b32 v8, v14
    v_fma_f32 v9, v9, v15, v12
    v_cvt_pk_bf16_f32 v12, v12, v12
    v_add_f32 v9, v9, v13
    v_cvt_pk_bf16_f32 v13, v13, v13
    v_mul_f32 v24, v24, v15
    v_mul_f32 v25, v25, v15
    v_mul_f32 v26, v26, v15
    v_mul_f32 v27, v27, v15
    v_mul_f32 v28, v28, v15
    v_mul_f32 v29, v29, v15
    v_mul_f32 v30, v30, v15
    v_mul_f32 v31, v31, v15
    s_waitcnt vmcnt(13)
    v_and_b32 v16, v12, v4
    v_and_b32 v17, v12, v5
    v_and_b32 v18, v12, v6
    v_and_b32 v19, v12, v7
    v_and_b32_dpp v20, v12, v4 row_ror:8 row_mask:0xf bank_mask:0xf
    v_and_b32_dpp v21, v12, v5 row_ror:8 row_mask:0xf bank_mask:0xf
    v_and_b32_dpp v22, v12, v6 row_ror:8 row_mask:0xf bank_mask:0xf
    v_and_b32_dpp v23, v12, v7 row_ror:8 row_mask:0xf bank_mask:0xf
    v_mfma_f32_16x16x32_bf16 v[24:27], v[96:99], v[16:19], v[24:27]
    v_mfma_f32_16x16x32_bf16 v[28:31], v[100:103], v[16:19], v[28:31]
    v_mfma_f32_16x16x32_bf16 v[24:27], v[104:107], v[20:23], v[24:27]
    v_mfma_f32_16x16x32_bf16 v[28:31], v[108:111], v[20:23], v[28:31]
    s_cmp_eq_u32 s80, 0
    s_cbranch_scc1 L_SL2
    s_waitcnt vmcnt(4)
L_SL2:
    buffer_load_dwordx4 v[96:99], v2, s[44:47], s11 offen offset:0 nt
    buffer_load_dwordx4 v[100:103], v2, s[44:47], s11 offen offset:256 nt
    buffer_load_dwordx4 v[104:107], v2, s[44:47], s11 offen offset:512 nt
    buffer_load_dwordx4 v[108:111], v2, s[44:47], s11 offen offset:768 nt
    s_waitcnt vmcnt(13)
    v_and_b32 v16, v13, v4
    v_and_b32 v17, v13, v5
    v_and_b32 v18, v13, v6
    v_and_b32 v19, v13, v7
    v_and_b32_dpp v20, v13, v4 row_ror:8 row_mask:0xf bank_mask:0xf
    v_and_b32_dpp v21, v13, v5 row_ror:8 row_mask:0xf bank_mask:0xf
    v_and_b32_dpp v22, v13, v6 row_ror:8 row_mask:0xf bank_mask:0xf
    v_and_b32_dpp v23, v13, v7 row_ror:8 row_mask:0xf bank_mask:0xf
    v_mfma_f32_16x16x32_bf16 v[24:27], v[112:115], v[16:19], v[24:27]
    v_mfma_f32_16x16x32_bf16 v[28:31], v[116:119], v[16:19], v[28:31]
    v_mfma_f32_16x16x32_bf16 v[24:27], v[120:123], v[20:23], v[24:27]
    v_mfma_f32_16x16x32_bf16 v[28:31], v[124:127], v[20:23], v[28:31]
    s_cmp_eq_u32 s80, 0
    s_cbranch_scc1 L_SL3
    s_waitcnt vmcnt(4)
L_SL3:
    buffer_load_dwordx4 v[112:115], v2, s[44:47], s76 offen offset:0 nt
    buffer_load_dwordx4 v[116:119], v2, s[44:47], s76 offen offset:256 nt
    buffer_load_dwordx4 v[120:123], v2, s[44:47], s76 offen offset:512 nt
    buffer_load_dwordx4 v[124:127], v2, s[44:47], s76 offen offset:768 nt
    s_mov_b32 s12, s8
    s_cmp_eq_u32 s77, 0
    s_cbranch_scc1 L_LOOP
    s_mov_b32 s79, 0
L_DOSTAT:
    s_nop 3
    s_cmp_lg_u32 s81, 2
    s_cbranch_scc1 L_NOWT0
    s_waitcnt vmcnt(32)
L_NOWT0:
    v_dot2_f32_bf16 v14, v128, v32, 0
    v_dot2_f32_bf16 v15, v136, v40, 0
    v_dot2_f32_bf16 v14, v129, v33, v14
    v_dot2_f32_bf16 v15, v137, v41, v15
    v_dot2_f32_bf16 v14, v130, v34, v14
    v_dot2_f32_bf16 v15, v138, v42, v15
    v_dot2_f32_bf16 v14, v131, v35, v14
    v_dot2_f32_bf16 v15, v139, v43, v15
    v_dot2_f32_bf16 v14, v132, v36, v14
    v_dot2_f32_bf16 v15, v140, v44, v15
    v_dot2_f32_bf16 v14, v133, v37, v14
    v_dot2_f32_bf16 v15, v141, v45, v15
    v_dot2_f32_bf16 v14, v134, v38, v14
    v_dot2_f32_bf16 v15, v142, v46, v15
    v_dot2_f32_bf16 v14, v135, v39, v14
    v_dot2_f32_bf16 v15, v143, v47, v15
    s_nop 2
    v_add_f32 v12, v14, v15
    v_dot2_f32_bf16 v14, v144, v32, 0
    v_dot2_f32_bf16 v15, v152, v40, 0
    v_dot2_f32_bf16 v14, v145, v33, v14
    v_dot2_f32_bf16 v15, v153, v41, v15
    v_dot2_f32_bf16 v14, v146, v34, v14
    v_dot2_f32_bf16 v15, v154, v42, v15
    v_dot2_f32_bf16 v14, v147, v35, v14
    v_dot2_f32_bf16 v15, v155, v43, v15
    v_dot2_f32_bf16 v14, v148, v36, v14
    v_dot2_f32_bf16 v15, v156, v44, v15
    v_dot2_f32_bf16 v14, v149, v37, v14
    v_dot2_f32_bf16 v15, v157, v45, v15
    v_dot2_f32_bf16 v14, v150, v38, v14
    v_dot2_f32_bf16 v15, v158, v46, v15
    v_dot2_f32_bf16 v14, v151, v39, v14
    v_dot2_f32_bf16 v15, v159, v47, v15
    s_nop 2
    v_add_f32 v13, v14, v15
    s_nop 0
    v_add_f32_dpp v12, v12, v12 quad_perm:[1,0,3,2] row_mask:0xf bank_mask:0xf
    v_add_f32_dpp v13, v13, v13 quad_perm:[1,0,3,2] row_mask:0xf bank_mask:0xf
    s_nop 0
    s_nop 0
    v_add_f32_dpp v12, v12, v12 quad_perm:[2,3,0,1] row_mask:0xf bank_mask:0xf
    v_add_f32_dpp v13, v13, v13 quad_perm:[2,3,0,1] row_mask:0xf bank_mask:0xf
    s_nop 0
    s_nop 0
    v_add_f32_dpp v12, v12, v12 row_half_mirror row_mask:0xf bank_mask:0xf
    v_add_f32_dpp v13, v13, v13 row_half_mirror row_mask:0xf bank_mask:0xf
    s_nop 0
    v_cvt_pk_bf16_f32 v15, v12, v13
    v_lshlrev_b32 v12, 16, v15
    v_and_b32 v13, 0xffff0000, v15
    v_max_f32 v14, v12, v13
    s_nop 1
    v_max_f32_dpp v14, v14, v14 row_ror:8 row_mask:0xf bank_mask:0xf
    v_mov_b32 v15, v14
    s_nop 1
    v_permlane16_swap_b32 v14, v15
    s_nop 0
    v_max_f32 v14, v14, v15
    v_mov_b32 v15, v14
    s_nop 1
    v_permlane32_swap_b32 v14, v15
    s_nop 0
    v_max_f32 v14, v14, v15
    v_mul_f32 v14, s72, v14
    v_ceil_f32 v14, v14
    v_max_f32 v14, v14, v8
    v_sub_f32 v15, v8, v14
    v_fma_f32 v12, v12, s72, -v14
    v_fma_f32 v13, v13, s72, -v14
    v_exp_f32 v15, v15
    v_exp_f32 v12, v12
    v_exp_f32 v13, v13
    v_mov_b32 v8, v14
    v_fma_f32 v9, v9, v15, v12
    v_cvt_pk_bf16_f32 v12, v12, v12
    v_add_f32 v9, v9, v13
    v_cvt_pk_bf16_f32 v13, v13, v13
    v_mul_f32 v24, v24, v15
    v_mul_f32 v25, v25, v15
    v_mul_f32 v26, v26, v15
    v_mul_f32 v27, v27, v15
    v_mul_f32 v28, v28, v15
    v_mul_f32 v29, v29, v15
    v_mul_f32 v30, v30, v15
    v_mul_f32 v31, v31, v15
    v_and_b32 v16, v12, v4
    v_and_b32 v17, v12, v5
    v_and_b32 v18, v12, v6
    v_and_b32 v19, v12, v7
    v_and_b32_dpp v20, v12, v4 row_ror:8 row_mask:0xf bank_mask:0xf
    v_and_b32_dpp v21, v12, v5 row_ror:8 row_mask:0xf bank_mask:0xf
    v_and_b32_dpp v22, v12, v6 row_ror:8 row_mask:0xf bank_mask:0xf
    v_and_b32_dpp v23, v12, v7 row_ror:8 row_mask:0xf bank_mask:0xf
    v_mfma_f32_16x16x32_bf16 v[24:27], a[0:3], v[16:19], v[24:27]
    v_mfma_f32_16x16x32_bf16 v[28:31], a[4:7], v[16:19], v[28:31]
    v_mfma_f32_16x16x32_bf16 v[24:27], a[8:11], v[20:23], v[24:27]
    v_mfma_f32_16x16x32_bf16 v[28:31], a[12:15], v[20:23], v[28:31]
    v_and_b32 v16, v13, v4
    v_and_b32 v17, v13, v5
    v_and_b32 v18, v13, v6
    v_and_b32 v19, v13, v7
    v_and_b32_dpp v20, v13, v4 row_ror:8 row_mask:0xf bank_mask:0xf
    v_and_b32_dpp v21, v13, v5 row_ror:8 row_mask:0xf bank_mask:0xf
    v_and_b32_dpp v22, v13, v6 row_ror:8 row_mask:0xf bank_mask:0xf
    v_and_b32_dpp v23, v13, v7 row_ror:8 row_mask:0xf bank_mask:0xf
    v_mfma_f32_16x16x32_bf16 v[24:27], a[16:19], v[16:19], v[24:27]
    v_mfma_f32_16x16x32_bf16 v[28:31], a[20:23], v[16:19], v[28:31]
    v_mfma_f32_16x16x32_bf16 v[24:27], a[24:27], v[20:23], v[24:27]
    v_mfma_f32_16x16x32_bf16 v[28:31], a[28:31], v[20:23], v[28:31]
    s_cmp_lg_u32 s81, 1
    s_cbranch_scc1 L_NORA0
    s_add_u32 s74, s75, 0
    buffer_load_dwordx4 v[128:131], v1, s[40:43], s74 offen offset:0 nt
    buffer_load_dwordx4 v[132:135], v1, s[40:43], s74 offen offset:128 nt
    buffer_load_dwordx4 v[136:139], v1, s[40:43], s74 offen offset:256 nt
    buffer_load_dwordx4 v[140:143], v1, s[40:43], s74 offen offset:384 nt
    s_add_u32 s74, s75, 245760
    buffer_load_dwordx4 v[144:147], v1, s[40:43], s74 offen offset:0 nt
    buffer_load_dwordx4 v[148:151], v1, s[40:43], s74 offen offset:128 nt
    buffer_load_dwordx4 v[152:155], v1, s[40:43], s74 offen offset:256 nt
    buffer_load_dwordx4 v[156:159], v1, s[40:43], s74 offen offset:384 nt
    s_add_u32 s74, s75, 0
    buffer_load_dwordx4 a[0:3], v2, s[44:47], s74 offen offset:0 nt
    buffer_load_dwordx4 a[4:7], v2, s[44:47], s74 offen offset:256 nt
    buffer_load_dwordx4 a[8:11], v2, s[44:47], s74 offen offset:512 nt
    buffer_load_dwordx4 a[12:15], v2, s[44:47], s74 offen offset:768 nt
    s_add_u32 s74, s75, 245760
    buffer_load_dwordx4 a[16:19], v2, s[44:47], s74 offen offset:0 nt
    buffer_load_dwordx4 a[20:23], v2, s[44:47], s74 offen offset:256 nt
    buffer_load_dwordx4 a[24:27], v2, s[44:47], s74 offen offset:512 nt
    buffer_load_dwordx4 a[28:31], v2, s[44:47], s74 offen offset:768 nt
L_NORA0:
    s_cmp_lg_u32 s81, 2
    s_cbranch_scc1 L_NORB0
    s_add_u32 s74, s75, 1474560
    buffer_load_dwordx4 v[224:227], v1, s[40:43], s74 offen offset:0 nt
    buffer_load_dwordx4 v[228:231], v1, s[40:43], s74 offen offset:128 nt
    buffer_load_dwordx4 v[232:235], v1, s[40:43], s74 offen offset:256 nt
    buffer_load_dwordx4 v[236:239], v1, s[40:43], s74 offen offset:384 nt
    s_add_u32 s74, s75, 1720320
    buffer_load_dwordx4 v[240:243], v1, s[40:43], s74 offen offset:0 nt
    buffer_load_dwordx4 v[244:247], v1, s[40:43], s74 offen offset:128 nt
    buffer_load_dwordx4 v[248:251], v1, s[40:43], s74 offen offset:256 nt
    buffer_load_dwordx4 v[252:255], v1, s[40:43], s74 offen offset:384 nt
    s_add_u32 s74, s75, 1474560
    buffer_load_dwordx4 a[96:99], v2, s[44:47], s74 offen offset:0 nt
    buffer_load_dwordx4 a[100:103], v2, s[44:47], s74 offen offset:256 nt
    buffer_load_dwordx4 a[104:107], v2, s[44:47], s74 offen offset:512 nt
    buffer_load_dwordx4 a[108:111], v2, s[44:47], s74 offen offset:768 nt
    s_add_u32 s74, s75, 1720320
    buffer_load_dwordx4 a[112:115], v2, s[44:47], s74 offen offset:0 nt
    buffer_load_dwordx4 a[116:119], v2, s[44:47], s74 offen offset:256 nt
    buffer_load_dwordx4 a[120:123], v2, s[44:47], s74 offen offset:512 nt
    buffer_load_dwordx4 a[124:127], v2, s[44:47], s74 offen offset:768 nt
L_NORB0:
    s_nop 2
    s_cmp_lg_u32 s81, 2
    s_cbranch_scc1 L_NOWT1
    s_waitcnt vmcnt(32)
L_NOWT1:
    v_dot2_f32_bf16 v14, v160, v32, 0
    v_dot2_f32_bf16 v15, v168, v40, 0
    v_dot2_f32_bf16 v14, v161, v33, v14
    v_dot2_f32_bf16 v15, v169, v41, v15
    v_dot2_f32_bf16 v14, v162, v34, v14
    v_dot2_f32_bf16 v15, v170, v42, v15
    v_dot2_f32_bf16 v14, v163, v35, v14
    v_dot2_f32_bf16 v15, v171, v43, v15
    v_dot2_f32_bf16 v14, v164, v36, v14
    v_dot2_f32_bf16 v15, v172, v44, v15
    v_dot2_f32_bf16 v14, v165, v37, v14
    v_dot2_f32_bf16 v15, v173, v45, v15
    v_dot2_f32_bf16 v14, v166, v38, v14
    v_dot2_f32_bf16 v15, v174, v46, v15
    v_dot2_f32_bf16 v14, v167, v39, v14
    v_dot2_f32_bf16 v15, v175, v47, v15
    s_nop 2
    v_add_f32 v12, v14, v15
    v_dot2_f32_bf16 v14, v176, v32, 0
    v_dot2_f32_bf16 v15, v184, v40, 0
    v_dot2_f32_bf16 v14, v177, v33, v14
    v_dot2_f32_bf16 v15, v185, v41, v15
    v_dot2_f32_bf16 v14, v178, v34, v14
    v_dot2_f32_bf16 v15, v186, v42, v15
    v_dot2_f32_bf16 v14, v179, v35, v14
    v_dot2_f32_bf16 v15, v187, v43, v15
    v_dot2_f32_bf16 v14, v180, v36, v14
    v_dot2_f32_bf16 v15, v188, v44, v15
    v_dot2_f32_bf16 v14, v181, v37, v14
    v_dot2_f32_bf16 v15, v189, v45, v15
    v_dot2_f32_bf16 v14, v182, v38, v14
    v_dot2_f32_bf16 v15, v190, v46, v15
    v_dot2_f32_bf16 v14, v183, v39, v14
    v_dot2_f32_bf16 v15, v191, v47, v15
    s_nop 2
    v_add_f32 v13, v14, v15
    s_nop 0
    v_add_f32_dpp v12, v12, v12 quad_perm:[1,0,3,2] row_mask:0xf bank_mask:0xf
    v_add_f32_dpp v13, v13, v13 quad_perm:[1,0,3,2] row_mask:0xf bank_mask:0xf
    s_nop 0
    s_nop 0
    v_add_f32_dpp v12, v12, v12 quad_perm:[2,3,0,1] row_mask:0xf bank_mask:0xf
    v_add_f32_dpp v13, v13, v13 quad_perm:[2,3,0,1] row_mask:0xf bank_mask:0xf
    s_nop 0
    s_nop 0
    v_add_f32_dpp v12, v12, v12 row_half_mirror row_mask:0xf bank_mask:0xf
    v_add_f32_dpp v13, v13, v13 row_half_mirror row_mask:0xf bank_mask:0xf
    s_nop 0
    v_cvt_pk_bf16_f32 v15, v12, v13
    v_lshlrev_b32 v12, 16, v15
    v_and_b32 v13, 0xffff0000, v15
    v_max_f32 v14, v12, v13
    s_nop 1
    v_max_f32_dpp v14, v14, v14 row_ror:8 row_mask:0xf bank_mask:0xf
    v_mov_b32 v15, v14
    s_nop 1
    v_permlane16_swap_b32 v14, v15
    s_nop 0
    v_max_f32 v14, v14, v15
    v_mov_b32 v15, v14
    s_nop 1
    v_permlane32_swap_b32 v14, v15
    s_nop 0
    v_max_f32 v14, v14, v15
    v_mul_f32 v14, s72, v14
    v_ceil_f32 v14, v14
    v_max_f32 v14, v14, v8
    v_sub_f32 v15, v8, v14
    v_fma_f32 v12, v12, s72, -v14
    v_fma_f32 v13, v13, s72, -v14
    v_exp_f32 v15, v15
    v_exp_f32 v12, v12
    v_exp_f32 v13, v13
    v_mov_b32 v8, v14
    v_fma_f32 v9, v9, v15, v12
    v_cvt_pk_bf16_f32 v12, v12, v12
    v_add_f32 v9, v9, v13
    v_cvt_pk_bf16_f32 v13, v13, v13
    v_mul_f32 v24, v24, v15
    v_mul_f32 v25, v25, v15
    v_mul_f32 v26, v26, v15
    v_mul_f32 v27, v27, v15
    v_mul_f32 v28, v28, v15
    v_mul_f32 v29, v29, v15
    v_mul_f32 v30, v30, v15
    v_mul_f32 v31, v31, v15
    v_and_b32 v16, v12, v4
    v_and_b32 v17, v12, v5
    v_and_b32 v18, v12, v6
    v_and_b32 v19, v12, v7
    v_and_b32_dpp v20, v12, v4 row_ror:8 row_mask:0xf bank_mask:0xf
    v_and_b32_dpp v21, v12, v5 row_ror:8 row_mask:0xf bank_mask:0xf
    v_and_b32_dpp v22, v12, v6 row_ror:8 row_mask:0xf bank_mask:0xf
    v_and_b32_dpp v23, v12, v7 row_ror:8 row_mask:0xf bank_mask:0xf
    v_mfma_f32_16x16x32_bf16 v[24:27], a[32:35], v[16:19], v[24:27]
    v_mfma_f32_16x16x32_bf16 v[28:31], a[36:39], v[16:19], v[28:31]
    v_mfma_f32_16x16x32_bf16 v[24:27], a[40:43], v[20:23], v[24:27]
    v_mfma_f32_16x16x32_bf16 v[28:31], a[44:47], v[20:23], v[28:31]
    v_and_b32 v16, v13, v4
    v_and_b32 v17, v13, v5
    v_and_b32 v18, v13, v6
    v_and_b32 v19, v13, v7
    v_and_b32_dpp v20, v13, v4 row_ror:8 row_mask:0xf bank_mask:0xf
    v_and_b32_dpp v21, v13, v5 row_ror:8 row_mask:0xf bank_mask:0xf
    v_and_b32_dpp v22, v13, v6 row_ror:8 row_mask:0xf bank_mask:0xf
    v_and_b32_dpp v23, v13, v7 row_ror:8 row_mask:0xf bank_mask:0xf
    v_mfma_f32_16x16x32_bf16 v[24:27], a[48:51], v[16:19], v[24:27]
    v_mfma_f32_16x16x32_bf16 v[28:31], a[52:55], v[16:19], v[28:31]
    v_mfma_f32_16x16x32_bf16 v[24:27], a[56:59], v[20:23], v[24:27]
    v_mfma_f32_16x16x32_bf16 v[28:31], a[60:63], v[20:23], v[28:31]
    s_cmp_lg_u32 s81, 1
    s_cbranch_scc1 L_NORA1
    s_add_u32 s74, s75, 491520
    buffer_load_dwordx4 v[160:163], v1, s[40:43], s74 offen offset:0 nt
    buffer_load_dwordx4 v[164:167], v1, s[40:43], s74 offen offset:128 nt
    buffer_load_dwordx4 v[168:171], v1, s[40:43], s74 offen offset:256 nt
    buffer_load_dwordx4 v[172:175], v1, s[40:43], s74 offen offset:384 nt
    s_add_u32 s74, s75, 737280
    buffer_load_dwordx4 v[176:179], v1, s[40:43], s74 offen offset:0 nt
    buffer_load_dwordx4 v[180:183], v1, s[40:43], s74 offen offset:128 nt
    buffer_load_dwordx4 v[184:187], v1, s[40:43], s74 offen offset:256 nt
    buffer_load_dwordx4 v[188:191], v1, s[40:43], s74 offen offset:384 nt
    s_add_u32 s74, s75, 491520
    buffer_load_dwordx4 a[32:35], v2, s[44:47], s74 offen offset:0 nt
    buffer_load_dwordx4 a[36:39], v2, s[44:47], s74 offen offset:256 nt
    buffer_load_dwordx4 a[40:43], v2, s[44:47], s74 offen offset:512 nt
    buffer_load_dwordx4 a[44:47], v2, s[44:47], s74 offen offset:768 nt
    s_add_u32 s74, s75, 737280
    buffer_load_dwordx4 a[48:51], v2, s[44:47], s74 offen offset:0 nt
    buffer_load_dwordx4 a[52:55], v2, s[44:47], s74 offen offset:256 nt
    buffer_load_dwordx4 a[56:59], v2, s[44:47], s74 offen offset:512 nt
    buffer_load_dwordx4 a[60:63], v2, s[44:47], s74 offen offset:768 nt
L_NORA1:
    s_cmp_lg_u32 s81, 2
    s_cbranch_scc1 L_NORB1
    s_add_u32 s74, s75, 1966080
    s_add_u32 m0, s78, 0
    s_nop 0
    buffer_load_dwordx4 v1, s[40:43], s74 offen offset:0 nt lds
    s_add_u32 m0, s78, 896
    s_nop 0
    buffer_load_dwordx4 v1, s[40:43], s74 offen offset:128 nt lds
    s_add_u32 m0, s78, 1792
    s_nop 0
    buffer_load_dwordx4 v1, s[40:43], s74 offen offset:256 nt lds
    s_add_u32 m0, s78, 2688
    s_nop 0
    buffer_load_dwordx4 v1, s[40:43], s74 offen offset:384 nt lds
    s_add_u32 s74, s75, 2211840
    s_add_u32 m0, s78, 4096
    s_nop 0
    buffer_load_dwordx4 v1, s[40:43], s74 offen offset:0 nt lds
    s_add_u32 m0, s78, 4992
    s_nop 0
    buffer_load_dwordx4 v1, s[40:43], s74 offen offset:128 nt lds
    s_add_u32 m0, s78, 5888
    s_nop 0
    buffer_load_dwordx4 v1, s[40:43], s74 offen offset:256 nt lds
    s_add_u32 m0, s78, 6784
    s_nop 0
    buffer_load_dwordx4 v1, s[40:43], s74 offen offset:384 nt lds
    s_add_u32 s74, s75, 1966080
    buffer_load_dwordx4 a[128:131], v2, s[44:47], s74 offen offset:0 nt
    buffer_load_dwordx4 a[132:135], v2, s[44:47], s74 offen offset:256 nt
    buffer_load_dwordx4 a[136:139], v2, s[44:47], s74 offen offset:512 nt
    buffer_load_dwordx4 a[140:143], v2, s[44:47], s74 offen offset:768 nt
    s_add_u32 s74, s75, 2211840
    buffer_load_dwordx4 a[144:147], v2, s[44:47], s74 offen offset:0 nt
    buffer_load_dwordx4 a[148:151], v2, s[44:47], s74 offen offset:256 nt
    buffer_load_dwordx4 a[152:155], v2, s[44:47], s74 offen offset:512 nt
    buffer_load_dwordx4 a[156:159], v2, s[44:47], s74 offen offset:768 nt
L_NORB1:
    s_nop 2
    s_cmp_lg_u32 s81, 2
    s_cbranch_scc1 L_NOWT2
    s_waitcnt vmcnt(32)
L_NOWT2:
    v_dot2_f32_bf16 v14, v192, v32, 0
    v_dot2_f32_bf16 v15, v200, v40, 0
    v_dot2_f32_bf16 v14, v193, v33, v14
    v_dot2_f32_bf16 v15, v201, v41, v15
    v_dot2_f32_bf16 v14, v194, v34, v14
    v_dot2_f32_bf16 v15, v202, v42, v15
    v_dot2_f32_bf16 v14, v195, v35, v14
    v_dot2_f32_bf16 v15, v203, v43, v15
    v_dot2_f32_bf16 v14, v196, v36, v14
    v_dot2_f32_bf16 v15, v204, v44, v15
    v_dot2_f32_bf16 v14, v197, v37, v14
    v_dot2_f32_bf16 v15, v205, v45, v15
    v_dot2_f32_bf16 v14, v198, v38, v14
    v_dot2_f32_bf16 v15, v206, v46, v15
    v_dot2_f32_bf16 v14, v199, v39, v14
    v_dot2_f32_bf16 v15, v207, v47, v15
    s_nop 2
    v_add_f32 v12, v14, v15
    v_dot2_f32_bf16 v14, v208, v32, 0
    v_dot2_f32_bf16 v15, v216, v40, 0
    v_dot2_f32_bf16 v14, v209, v33, v14
    v_dot2_f32_bf16 v15, v217, v41, v15
    v_dot2_f32_bf16 v14, v210, v34, v14
    v_dot2_f32_bf16 v15, v218, v42, v15
    v_dot2_f32_bf16 v14, v211, v35, v14
    v_dot2_f32_bf16 v15, v219, v43, v15
    v_dot2_f32_bf16 v14, v212, v36, v14
    v_dot2_f32_bf16 v15, v220, v44, v15
    v_dot2_f32_bf16 v14, v213, v37, v14
    v_dot2_f32_bf16 v15, v221, v45, v15
    v_dot2_f32_bf16 v14, v214, v38, v14
    v_dot2_f32_bf16 v15, v222, v46, v15
    v_dot2_f32_bf16 v14, v215, v39, v14
    v_dot2_f32_bf16 v15, v223, v47, v15
    s_nop 2
    v_add_f32 v13, v14, v15
    s_nop 0
    v_add_f32_dpp v12, v12, v12 quad_perm:[1,0,3,2] row_mask:0xf bank_mask:0xf
    v_add_f32_dpp v13, v13, v13 quad_perm:[1,0,3,2] row_mask:0xf bank_mask:0xf
    s_nop 0
    s_nop 0
    v_add_f32_dpp v12, v12, v12 quad_perm:[2,3,0,1] row_mask:0xf bank_mask:0xf
    v_add_f32_dpp v13, v13, v13 quad_perm:[2,3,0,1] row_mask:0xf bank_mask:0xf
    s_nop 0
    s_nop 0
    v_add_f32_dpp v12, v12, v12 row_half_mirror row_mask:0xf bank_mask:0xf
    v_add_f32_dpp v13, v13, v13 row_half_mirror row_mask:0xf bank_mask:0xf
    s_nop 0
    v_cvt_pk_bf16_f32 v15, v12, v13
    v_lshlrev_b32 v12, 16, v15
    v_and_b32 v13, 0xffff0000, v15
    v_max_f32 v14, v12, v13
    s_nop 1
    v_max_f32_dpp v14, v14, v14 row_ror:8 row_mask:0xf bank_mask:0xf
    v_mov_b32 v15, v14
    s_nop 1
    v_permlane16_swap_b32 v14, v15
    s_nop 0
    v_max_f32 v14, v14, v15
    v_mov_b32 v15, v14
    s_nop 1
    v_permlane32_swap_b32 v14, v15
    s_nop 0
    v_max_f32 v14, v14, v15
    v_mul_f32 v14, s72, v14
    v_ceil_f32 v14, v14
    v_max_f32 v14, v14, v8
    v_sub_f32 v15, v8, v14
    v_fma_f32 v12, v12, s72, -v14
    v_fma_f32 v13, v13, s72, -v14
    v_exp_f32 v15, v15
    v_exp_f32 v12, v12
    v_exp_f32 v13, v13
    v_mov_b32 v8, v14
    v_fma_f32 v9, v9, v15, v12
    v_cvt_pk_bf16_f32 v12, v12, v12
    v_add_f32 v9, v9, v13
    v_cvt_pk_bf16_f32 v13, v13, v13
    v_mul_f32 v24, v24, v15
    v_mul_f32 v25, v25, v15
    v_mul_f32 v26, v26, v15
    v_mul_f32 v27, v27, v15
    v_mul_f32 v28, v28, v15
    v_mul_f32 v29, v29, v15
    v_mul_f32 v30, v30, v15
    v_mul_f32 v31, v31, v15
    v_and_b32 v16, v12, v4
    v_and_b32 v17, v12, v5
    v_and_b32 v18, v12, v6
    v_and_b32 v19, v12, v7
    v_and_b32_dpp v20, v12, v4 row_ror:8 row_mask:0xf bank_mask:0xf
    v_and_b32_dpp v21, v12, v5 row_ror:8 row_mask:0xf bank_mask:0xf
    v_and_b32_dpp v22, v12, v6 row_ror:8 row_mask:0xf bank_mask:0xf
    v_and_b32_dpp v23, v12, v7 row_ror:8 row_mask:0xf bank_mask:0xf
    v_mfma_f32_16x16x32_bf16 v[24:27], a[64:67], v[16:19], v[24:27]
    v_mfma_f32_16x16x32_bf16 v[28:31], a[68:71], v[16:19], v[28:31]
    v_mfma_f32_16x16x32_bf16 v[24:27], a[72:75], v[20:23], v[24:27]
    v_mfma_f32_16x16x32_bf16 v[28:31], a[76:79], v[20:23], v[28:31]
    v_and_b32 v16, v13, v4
    v_and_b32 v17, v13, v5
    v_and_b32 v18, v13, v6
    v_and_b32 v19, v13, v7
    v_and_b32_dpp v20, v13, v4 row_ror:8 row_mask:0xf bank_mask:0xf
    v_and_b32_dpp v21, v13, v5 row_ror:8 row_mask:0xf bank_mask:0xf
    v_and_b32_dpp v22, v13, v6 row_ror:8 row_mask:0xf bank_mask:0xf
    v_and_b32_dpp v23, v13, v7 row_ror:8 row_mask:0xf bank_mask:0xf
    v_mfma_f32_16x16x32_bf16 v[24:27], a[80:83], v[16:19], v[24:27]
    v_mfma_f32_16x16x32_bf16 v[28:31], a[84:87], v[16:19], v[28:31]
    v_mfma_f32_16x16x32_bf16 v[24:27], a[88:91], v[20:23], v[24:27]
    v_mfma_f32_16x16x32_bf16 v[28:31], a[92:95], v[20:23], v[28:31]
    s_cmp_lg_u32 s81, 1
    s_cbranch_scc1 L_NORA2
    s_add_u32 s74, s75, 983040
    buffer_load_dwordx4 v[192:195], v1, s[40:43], s74 offen offset:0 nt
    buffer_load_dwordx4 v[196:199], v1, s[40:43], s74 offen offset:128 nt
    buffer_load_dwordx4 v[200:203], v1, s[40:43], s74 offen offset:256 nt
    buffer_load_dwordx4 v[204:207], v1, s[40:43], s74 offen offset:384 nt
    s_add_u32 s74, s75, 1228800
    buffer_load_dwordx4 v[208:211], v1, s[40:43], s74 offen offset:0 nt
    buffer_load_dwordx4 v[212:215], v1, s[40:43], s74 offen offset:128 nt
    buffer_load_dwordx4 v[216:219], v1, s[40:43], s74 offen offset:256 nt
    buffer_load_dwordx4 v[220:223], v1, s[40:43], s74 offen offset:384 nt
    s_add_u32 s74, s75, 983040
    buffer_load_dwordx4 a[64:67], v2, s[44:47], s74 offen offset:0 nt
    buffer_load_dwordx4 a[68:71], v2, s[44:47], s74 offen offset:256 nt
    buffer_load_dwordx4 a[72:75], v2, s[44:47], s74 offen offset:512 nt
    buffer_load_dwordx4 a[76:79], v2, s[44:47], s74 offen offset:768 nt
    s_add_u32 s74, s75, 1228800
    buffer_load_dwordx4 a[80:83], v2, s[44:47], s74 offen offset:0 nt
    buffer_load_dwordx4 a[84:87], v2, s[44:47], s74 offen offset:256 nt
    buffer_load_dwordx4 a[88:91], v2, s[44:47], s74 offen offset:512 nt
    buffer_load_dwordx4 a[92:95], v2, s[44:47], s74 offen offset:768 nt
L_NORA2:
    s_cmp_lg_u32 s81, 2
    s_cbranch_scc1 L_NORB2
    s_add_u32 s74, s75, 2457600
    s_add_u32 m0, s78, 8192
    s_nop 0
    buffer_load_dwordx4 v1, s[40:43], s74 offen offset:0 nt lds
    s_add_u32 m0, s78, 9088
    s_nop 0
    buffer_load_dwordx4 v1, s[40:43], s74 offen offset:128 nt lds
    s_add_u32 m0, s78, 9984
    s_nop 0
    buffer_load_dwordx4 v1, s[40:43], s74 offen offset:256 nt lds
    s_add_u32 m0, s78, 10880
    s_nop 0
    buffer_load_dwordx4 v1, s[40:43], s74 offen offset:384 nt lds
    s_add_u32 s74, s75, 2703360
    s_add_u32 m0, s78, 12288
    s_nop 0
    buffer_load_dwordx4 v1, s[40:43], s74 offen offset:0 nt lds
    s_add_u32 m0, s78, 13184
    s_nop 0
    buffer_load_dwordx4 v1, s[40:43], s74 offen offset:128 nt lds
    s_add_u32 m0, s78, 14080
    s_nop 0
    buffer_load_dwordx4 v1, s[40:43], s74 offen offset:256 nt lds
    s_add_u32 m0, s78, 14976
    s_nop 0
    buffer_load_dwordx4 v1, s[40:43], s74 offen offset:384 nt lds
    s_add_u32 s74, s75, 2457600
    buffer_load_dwordx4 a[160:163], v2, s[44:47], s74 offen offset:0 nt
    buffer_load_dwordx4 a[164:167], v2, s[44:47], s74 offen offset:256 nt
    buffer_load_dwordx4 a[168:171], v2, s[44:47], s74 offen offset:512 nt
    buffer_load_dwordx4 a[172:175], v2, s[44:47], s74 offen offset:768 nt
    s_add_u32 s74, s75, 2703360
    buffer_load_dwordx4 a[176:179], v2, s[44:47], s74 offen offset:0 nt
    buffer_load_dwordx4 a[180:183], v2, s[44:47], s74 offen offset:256 nt
    buffer_load_dwordx4 a[184:187], v2, s[44:47], s74 offen offset:512 nt
    buffer_load_dwordx4 a[188:191], v2, s[44:47], s74 offen offset:768 nt
L_NORB2:
    s_nop 2
    s_cmp_lg_u32 s81, 2
    s_cbranch_scc1 L_NOWT3
    s_waitcnt vmcnt(32)
L_NOWT3:
    v_dot2_f32_bf16 v14, v224, v32, 0
    v_dot2_f32_bf16 v15, v232, v40, 0
    v_dot2_f32_bf16 v14, v225, v33, v14
    v_dot2_f32_bf16 v15, v233, v41, v15
    v_dot2_f32_bf16 v14, v226, v34, v14
    v_dot2_f32_bf16 v15, v234, v42, v15
    v_dot2_f32_bf16 v14, v227, v35, v14
    v_dot2_f32_bf16 v15, v235, v43, v15
    v_dot2_f32_bf16 v14, v228, v36, v14
    v_dot2_f32_bf16 v15, v236, v44, v15
    v_dot2_f32_bf16 v14, v229, v37, v14
    v_dot2_f32_bf16 v15, v237, v45, v15
    v_dot2_f32_bf16 v14, v230, v38, v14
    v_dot2_f32_bf16 v15, v238, v46, v15
    v_dot2_f32_bf16 v14, v231, v39, v14
    v_dot2_f32_bf16 v15, v239, v47, v15
    s_nop 2
    v_add_f32 v12, v14, v15
    v_dot2_f32_bf16 v14, v240, v32, 0
    v_dot2_f32_bf16 v15, v248, v40, 0
    v_dot2_f32_bf16 v14, v241, v33, v14
    v_dot2_f32_bf16 v15, v249, v41, v15
    v_dot2_f32_bf16 v14, v242, v34, v14
    v_dot2_f32_bf16 v15, v250, v42, v15
    v_dot2_f32_bf16 v14, v243, v35, v14
    v_dot2_f32_bf16 v15, v251, v43, v15
    v_dot2_f32_bf16 v14, v244, v36, v14
    v_dot2_f32_bf16 v15, v252, v44, v15
    v_dot2_f32_bf16 v14, v245, v37, v14
    v_dot2_f32_bf16 v15, v253, v45, v15
    v_dot2_f32_bf16 v14, v246, v38, v14
    v_dot2_f32_bf16 v15, v254, v46, v15
    v_dot2_f32_bf16 v14, v247, v39, v14
    v_dot2_f32_bf16 v15, v255, v47, v15
    s_nop 2
    v_add_f32 v13, v14, v15
    s_nop 0
    v_add_f32_dpp v12, v12, v12 quad_perm:[1,0,3,2] row_mask:0xf bank_mask:0xf
    v_add_f32_dpp v13, v13, v13 quad_perm:[1,0,3,2] row_mask:0xf bank_mask:0xf
    s_nop 0
    s_nop 0
    v_add_f32_dpp v12, v12, v12 quad_perm:[2,3,0,1] row_mask:0xf bank_mask:0xf
    v_add_f32_dpp v13, v13, v13 quad_perm:[2,3,0,1] row_mask:0xf bank_mask:0xf
    s_nop 0
    s_nop 0
    v_add_f32_dpp v12, v12, v12 row_half_mirror row_mask:0xf bank_mask:0xf
    v_add_f32_dpp v13, v13, v13 row_half_mirror row_mask:0xf bank_mask:0xf
    s_nop 0
    v_cvt_pk_bf16_f32 v15, v12, v13
    v_lshlrev_b32 v12, 16, v15
    v_and_b32 v13, 0xffff0000, v15
    v_max_f32 v14, v12, v13
    s_nop 1
    v_max_f32_dpp v14, v14, v14 row_ror:8 row_mask:0xf bank_mask:0xf
    v_mov_b32 v15, v14
    s_nop 1
    v_permlane16_swap_b32 v14, v15
    s_nop 0
    v_max_f32 v14, v14, v15
    v_mov_b32 v15, v14
    s_nop 1
    v_permlane32_swap_b32 v14, v15
    s_nop 0
    v_max_f32 v14, v14, v15
    v_mul_f32 v14, s72, v14
    v_ceil_f32 v14, v14
    v_max_f32 v14, v14, v8
    v_sub_f32 v15, v8, v14
    v_fma_f32 v12, v12, s72, -v14
    v_fma_f32 v13, v13, s72, -v14
    v_exp_f32 v15, v15
    v_exp_f32 v12, v12
    v_exp_f32 v13, v13
    v_mov_b32 v8, v14
    v_fma_f32 v9, v9, v15, v12
    v_cvt_pk_bf16_f32 v12, v12, v12
    v_add_f32 v9, v9, v13
    v_cvt_pk_bf16_f32 v13, v13, v13
    v_mul_f32 v24, v24, v15
    v_mul_f32 v25, v25, v15
    v_mul_f32 v26, v26, v15
    v_mul_f32 v27, v27, v15
    v_mul_f32 v28, v28, v15
    v_mul_f32 v29, v29, v15
    v_mul_f32 v30, v30, v15
    v_mul_f32 v31, v31, v15
    v_and_b32 v16, v12, v4
    v_and_b32 v17, v12, v5
    v_and_b32 v18, v12, v6
    v_and_b32 v19, v12, v7
    v_and_b32_dpp v20, v12, v4 row_ror:8 row_mask:0xf bank_mask:0xf
    v_and_b32_dpp v21, v12, v5 row_ror:8 row_mask:0xf bank_mask:0xf
    v_and_b32_dpp v22, v12, v6 row_ror:8 row_mask:0xf bank_mask:0xf
    v_and_b32_dpp v23, v12, v7 row_ror:8 row_mask:0xf bank_mask:0xf
    v_mfma_f32_16x16x32_bf16 v[24:27], a[96:99], v[16:19], v[24:27]
    v_mfma_f32_16x16x32_bf16 v[28:31], a[100:103], v[16:19], v[28:31]
    v_mfma_f32_16x16x32_bf16 v[24:27], a[104:107], v[20:23], v[24:27]
    v_mfma_f32_16x16x32_bf16 v[28:31], a[108:111], v[20:23], v[28:31]
    v_and_b32 v16, v13, v4
    v_and_b32 v17, v13, v5
    v_and_b32 v18, v13, v6
    v_and_b32 v19, v13, v7
    v_and_b32_dpp v20, v13, v4 row_ror:8 row_mask:0xf bank_mask:0xf
    v_and_b32_dpp v21, v13, v5 row_ror:8 row_mask:0xf bank_mask:0xf
    v_and_b32_dpp v22, v13, v6 row_ror:8 row_mask:0xf bank_mask:0xf
    v_and_b32_dpp v23, v13, v7 row_ror:8 row_mask:0xf bank_mask:0xf
    v_mfma_f32_16x16x32_bf16 v[24:27], a[112:115], v[16:19], v[24:27]
    v_mfma_f32_16x16x32_bf16 v[28:31], a[116:119], v[16:19], v[28:31]
    v_mfma_f32_16x16x32_bf16 v[24:27], a[120:123], v[20:23], v[24:27]
    v_mfma_f32_16x16x32_bf16 v[28:31], a[124:127], v[20:23], v[28:31]
    s_cmp_lg_u32 s81, 2
    s_cbranch_scc1 L_NORB3
    s_add_u32 s74, s75, 2949120
    s_add_u32 m0, s78, 16384
    s_nop 0
    buffer_load_dwordx4 v1, s[40:43], s74 offen offset:0 nt lds
    s_add_u32 m0, s78, 17280
    s_nop 0
    buffer_load_dwordx4 v1, s[40:43], s74 offen offset:128 nt lds
    s_add_u32 m0, s78, 18176
    s_nop 0
    buffer_load_dwordx4 v1, s[40:43], s74 offen offset:256 nt lds
    s_add_u32 m0, s78, 19072
    s_nop 0
    buffer_load_dwordx4 v1, s[40:43], s74 offen offset:384 nt lds
    s_add_u32 s74, s75, 3194880
    s_add_u32 m0, s78, 20480
    s_nop 0
    buffer_load_dwordx4 v1, s[40:43], s74 offen offset:0 nt lds
    s_add_u32 m0, s78, 21376
    s_nop 0
    buffer_load_dwordx4 v1, s[40:43], s74 offen offset:128 nt lds
    s_add_u32 m0, s78, 22272
    s_nop 0
    buffer_load_dwordx4 v1, s[40:43], s74 offen offset:256 nt lds
    s_add_u32 m0, s78, 23168
    s_nop 0
    buffer_load_dwordx4 v1, s[40:43], s74 offen offset:384 nt lds
    s_add_u32 s74, s75, 2949120
    buffer_load_dwordx4 a[192:195], v2, s[44:47], s74 offen offset:0 nt
    buffer_load_dwordx4 a[196:199], v2, s[44:47], s74 offen offset:256 nt
    buffer_load_dwordx4 a[200:203], v2, s[44:47], s74 offen offset:512 nt
    buffer_load_dwordx4 a[204:207], v2, s[44:47], s74 offen offset:768 nt
    s_add_u32 s74, s75, 3194880
    buffer_load_dwordx4 a[208:211], v2, s[44:47], s74 offen offset:0 nt
    buffer_load_dwordx4 a[212:215], v2, s[44:47], s74 offen offset:256 nt
    buffer_load_dwordx4 a[216:219], v2, s[44:47], s74 offen offset:512 nt
    buffer_load_dwordx4 a[220:223], v2, s[44:47], s74 offen offset:768 nt
L_NORB3:
    s_nop 2
    s_cmp_lg_u32 s81, 2
    s_cbranch_scc1 L_NOWT4
    s_waitcnt vmcnt(32)
L_NOWT4:
    v_lshl_add_u32 v13, v0, 4, s78
    ds_read_b128 v[16:19], v13 offset:0
    ds_read_b128 v[20:23], v13 offset:1024
    s_waitcnt lgkmcnt(1)
    v_dot2_f32_bf16 v14, v16, v32, 0
    v_dot2_f32_bf16 v14, v17, v33, v14
    v_dot2_f32_bf16 v14, v18, v34, v14
    v_dot2_f32_bf16 v14, v19, v35, v14
    ds_read_b128 v[16:19], v13 offset:2048
    s_waitcnt lgkmcnt(1)
    v_dot2_f32_bf16 v15, v20, v36, 0
    v_dot2_f32_bf16 v15, v21, v37, v15
    v_dot2_f32_bf16 v15, v22, v38, v15
    v_dot2_f32_bf16 v15, v23, v39, v15
    ds_read_b128 v[20:23], v13 offset:3072
    s_waitcnt lgkmcnt(1)
    v_dot2_f32_bf16 v14, v16, v40, v14
    v_dot2_f32_bf16 v14, v17, v41, v14
    v_dot2_f32_bf16 v14, v18, v42, v14
    v_dot2_f32_bf16 v14, v19, v43, v14
    s_waitcnt lgkmcnt(0)
    v_dot2_f32_bf16 v15, v20, v44, v15
    v_dot2_f32_bf16 v15, v21, v45, v15
    v_dot2_f32_bf16 v15, v22, v46, v15
    v_dot2_f32_bf16 v15, v23, v47, v15
    s_nop 2
    v_add_f32 v12, v14, v15
    ds_read_b128 v[16:19], v13 offset:4096
    ds_read_b128 v[20:23], v13 offset:5120
    s_waitcnt lgkmcnt(1)
    v_dot2_f32_bf16 v14, v16, v32, 0
    v_dot2_f32_bf16 v14, v17, v33, v14
    v_dot2_f32_bf16 v14, v18, v34, v14
    v_dot2_f32_bf16 v14, v19, v35, v14
    ds_read_b128 v[16:19], v13 offset:6144
    s_waitcnt lgkmcnt(1)
    v_dot2_f32_bf16 v15, v20, v36, 0
    v_dot2_f32_bf16 v15, v21, v37, v15
    v_dot2_f32_bf16 v15, v22, v38, v15
    v_dot2_f32_bf16 v15, v23, v39, v15
    ds_read_b128 v[20:23], v13 offset:7168
    s_waitcnt lgkmcnt(1)
    v_dot2_f32_bf16 v14, v16, v40, v14
    v_dot2_f32_bf16 v14, v17, v41, v14
    v_dot2_f32_bf16 v14, v18, v42, v14
    v_dot2_f32_bf16 v14, v19, v43, v14
    s_waitcnt lgkmcnt(0)
    v_dot2_f32_bf16 v15, v20, v44, v15
    v_dot2_f32_bf16 v15, v21, v45, v15
    v_dot2_f32_bf16 v15, v22, v46, v15
    v_dot2_f32_bf16 v15, v23, v47, v15
    s_nop 2
    v_add_f32 v13, v14, v15
    s_nop 0
    v_add_f32_dpp v12, v12, v12 quad_perm:[1,0,3,2] row_mask:0xf bank_mask:0xf
    v_add_f32_dpp v13, v13, v13 quad_perm:[1,0,3,2] row_mask:0xf bank_mask:0xf
    s_nop 0
    s_nop 0
    v_add_f32_dpp v12, v12, v12 quad_perm:[2,3,0,1] row_mask:0xf bank_mask:0xf
    v_add_f32_dpp v13, v13, v13 quad_perm:[2,3,0,1] row_mask:0xf bank_mask:0xf
    s_nop 0
    s_nop 0
    v_add_f32_dpp v12, v12, v12 row_half_mirror row_mask:0xf bank_mask:0xf
    v_add_f32_dpp v13, v13, v13 row_half_mirror row_mask:0xf bank_mask:0xf
    s_nop 0
    v_cvt_pk_bf16_f32 v15, v12, v13
    v_lshlrev_b32 v12, 16, v15
    v_and_b32 v13, 0xffff0000, v15
    v_max_f32 v14, v12, v13
    s_nop 1
    v_max_f32_dpp v14, v14, v14 row_ror:8 row_mask:0xf bank_mask:0xf
    v_mov_b32 v15, v14
    s_nop 1
    v_permlane16_swap_b32 v14, v15
    s_nop 0
    v_max_f32 v14, v14, v15
    v_mov_b32 v15, v14
    s_nop 1
    v_permlane32_swap_b32 v14, v15
    s_nop 0
    v_max_f32 v14, v14, v15
    v_mul_f32 v14, s72, v14
    v_ceil_f32 v14, v14
    v_max_f32 v14, v14, v8
    v_sub_f32 v15, v8, v14
    v_fma_f32 v12, v12, s72, -v14
    v_fma_f32 v13, v13, s72, -v14
    v_exp_f32 v15, v15
    v_exp_f32 v12, v12
    v_exp_f32 v13, v13
    v_mov_b32 v8, v14
    v_fma_f32 v9, v9, v15, v12
    v_cvt_pk_bf16_f32 v12, v12, v12
    v_add_f32 v9, v9, v13
    v_cvt_pk_bf16_f32 v13, v13, v13
    v_mul_f32 v24, v24, v15
    v_mul_f32 v25, v25, v15
    v_mul_f32 v26, v26, v15
    v_mul_f32 v27, v27, v15
    v_mul_f32 v28, v28, v15
    v_mul_f32 v29, v29, v15
    v_mul_f32 v30, v30, v15
    v_mul_f32 v31, v31, v15
    v_and_b32 v16, v12, v4
    v_and_b32 v17, v12, v5
    v_and_b32 v18, v12, v6
    v_and_b32 v19, v12, v7
    v_and_b32_dpp v20, v12, v4 row_ror:8 row_mask:0xf bank_mask:0xf
    v_and_b32_dpp v21, v12, v5 row_ror:8 row_mask:0xf bank_mask:0xf
    v_and_b32_dpp v22, v12, v6 row_ror:8 row_mask:0xf bank_mask:0xf
    v_and_b32_dpp v23, v12, v7 row_ror:8 row_mask:0xf bank_mask:0xf
    v_mfma_f32_16x16x32_bf16 v[24:27], a[128:131], v[16:19], v[24:27]
    v_mfma_f32_16x16x32_bf16 v[28:31], a[132:135], v[16:19], v[28:31]
    v_mfma_f32_16x16x32_bf16 v[24:27], a[136:139], v[20:23], v[24:27]
    v_mfma_f32_16x16x32_bf16 v[28:31], a[140:143], v[20:23], v[28:31]
    v_and_b32 v16, v13, v4
    v_and_b32 v17, v13, v5
    v_and_b32 v18, v13, v6
    v_and_b32 v19, v13, v7
    v_and_b32_dpp v20, v13, v4 row_ror:8 row_mask:0xf bank_mask:0xf
    v_and_b32_dpp v21, v13, v5 row_ror:8 row_mask:0xf bank_mask:0xf
    v_and_b32_dpp v22, v13, v6 row_ror:8 row_mask:0xf bank_mask:0xf
    v_and_b32_dpp v23, v13, v7 row_ror:8 row_mask:0xf bank_mask:0xf
    v_mfma_f32_16x16x32_bf16 v[24:27], a[144:147], v[16:19], v[24:27]
    v_mfma_f32_16x16x32_bf16 v[28:31], a[148:151], v[16:19], v[28:31]
    v_mfma_f32_16x16x32_bf16 v[24:27], a[152:155], v[20:23], v[24:27]
    v_mfma_f32_16x16x32_bf16 v[28:31], a[156:159], v[20:23], v[28:31]
    s_cmp_lg_u32 s81, 2
    s_cbranch_scc1 L_NORB4
    s_add_u32 s74, s75, 3440640
    s_add_u32 m0, s78, 24576
    s_nop 0
    buffer_load_dwordx4 v1, s[40:43], s74 offen offset:0 nt lds
    s_add_u32 m0, s78, 25472
    s_nop 0
    buffer_load_dwordx4 v1, s[40:43], s74 offen offset:128 nt lds
    s_add_u32 m0, s78, 26368
    s_nop 0
    buffer_load_dwordx4 v1, s[40:43], s74 offen offset:256 nt lds
    s_add_u32 m0, s78, 27264
    s_nop 0
    buffer_load_dwordx4 v1, s[40:43], s74 offen offset:384 nt lds
    s_add_u32 s74, s75, 3686400
    s_add_u32 m0, s78, 28672
    s_nop 0
    buffer_load_dwordx4 v1, s[40:43], s74 offen offset:0 nt lds
    s_add_u32 m0, s78, 29568
    s_nop 0
    buffer_load_dwordx4 v1, s[40:43], s74 offen offset:128 nt lds
    s_add_u32 m0, s78, 30464
    s_nop 0
    buffer_load_dwordx4 v1, s[40:43], s74 offen offset:256 nt lds
    s_add_u32 m0, s78, 31360
    s_nop 0
    buffer_load_dwordx4 v1, s[40:43], s74 offen offset:384 nt lds
    s_add_u32 s74, s75, 3440640
    buffer_load_dwordx4 a[224:227], v2, s[44:47], s74 offen offset:0 nt
    buffer_load_dwordx4 a[228:231], v2, s[44:47], s74 offen offset:256 nt
    buffer_load_dwordx4 a[232:235], v2, s[44:47], s74 offen offset:512 nt
    buffer_load_dwordx4 a[236:239], v2, s[44:47], s74 offen offset:768 nt
    s_add_u32 s74, s75, 3686400
    buffer_load_dwordx4 a[240:243], v2, s[44:47], s74 offen offset:0 nt
    buffer_load_dwordx4 a[244:247], v2, s[44:47], s74 offen offset:256 nt
    buffer_load_dwordx4 a[248:251], v2, s[44:47], s74 offen offset:512 nt
    buffer_load_dwordx4 a[252:255], v2, s[44:47], s74 offen offset:768 nt
L_NORB4:
    s_nop 2
    s_cmp_lg_u32 s81, 2
    s_cbranch_scc1 L_NOWT5
    s_waitcnt vmcnt(32)
L_NOWT5:
    v_lshl_add_u32 v13, v0, 4, s78
    ds_read_b128 v[16:19], v13 offset:8192
    ds_read_b128 v[20:23], v13 offset:9216
    s_waitcnt lgkmcnt(1)
    v_dot2_f32_bf16 v14, v16, v32, 0
    v_dot2_f32_bf16 v14, v17, v33, v14
    v_dot2_f32_bf16 v14, v18, v34, v14
    v_dot2_f32_bf16 v14, v19, v35, v14
    ds_read_b128 v[16:19], v13 offset:10240
    s_waitcnt lgkmcnt(1)
    v_dot2_f32_bf16 v15, v20, v36, 0
    v_dot2_f32_bf16 v15, v21, v37, v15
    v_dot2_f32_bf16 v15, v22, v38, v15
    v_dot2_f32_bf16 v15, v23, v39, v15
    ds_read_b128 v[20:23], v13 offset:11264
    s_waitcnt lgkmcnt(1)
    v_dot2_f32_bf16 v14, v16, v40, v14
    v_dot2_f32_bf16 v14, v17, v41, v14
    v_dot2_f32_bf16 v14, v18, v42, v14
    v_dot2_f32_bf16 v14, v19, v43, v14
    s_waitcnt lgkmcnt(0)
    v_dot2_f32_bf16 v15, v20, v44, v15
    v_dot2_f32_bf16 v15, v21, v45, v15
    v_dot2_f32_bf16 v15, v22, v46, v15
    v_dot2_f32_bf16 v15, v23, v47, v15
    s_nop 2
    v_add_f32 v12, v14, v15
    ds_read_b128 v[16:19], v13 offset:12288
    ds_read_b128 v[20:23], v13 offset:13312
    s_waitcnt lgkmcnt(1)
    v_dot2_f32_bf16 v14, v16, v32, 0
    v_dot2_f32_bf16 v14, v17, v33, v14
    v_dot2_f32_bf16 v14, v18, v34, v14
    v_dot2_f32_bf16 v14, v19, v35, v14
    ds_read_b128 v[16:19], v13 offset:14336
    s_waitcnt lgkmcnt(1)
    v_dot2_f32_bf16 v15, v20, v36, 0
    v_dot2_f32_bf16 v15, v21, v37, v15
    v_dot2_f32_bf16 v15, v22, v38, v15
    v_dot2_f32_bf16 v15, v23, v39, v15
    ds_read_b128 v[20:23], v13 offset:15360
    s_waitcnt lgkmcnt(1)
    v_dot2_f32_bf16 v14, v16, v40, v14
    v_dot2_f32_bf16 v14, v17, v41, v14
    v_dot2_f32_bf16 v14, v18, v42, v14
    v_dot2_f32_bf16 v14, v19, v43, v14
    s_waitcnt lgkmcnt(0)
    v_dot2_f32_bf16 v15, v20, v44, v15
    v_dot2_f32_bf16 v15, v21, v45, v15
    v_dot2_f32_bf16 v15, v22, v46, v15
    v_dot2_f32_bf16 v15, v23, v47, v15
    s_nop 2
    v_add_f32 v13, v14, v15
    s_nop 0
    v_add_f32_dpp v12, v12, v12 quad_perm:[1,0,3,2] row_mask:0xf bank_mask:0xf
    v_add_f32_dpp v13, v13, v13 quad_perm:[1,0,3,2] row_mask:0xf bank_mask:0xf
    s_nop 0
    s_nop 0
    v_add_f32_dpp v12, v12, v12 quad_perm:[2,3,0,1] row_mask:0xf bank_mask:0xf
    v_add_f32_dpp v13, v13, v13 quad_perm:[2,3,0,1] row_mask:0xf bank_mask:0xf
    s_nop 0
    s_nop 0
    v_add_f32_dpp v12, v12, v12 row_half_mirror row_mask:0xf bank_mask:0xf
    v_add_f32_dpp v13, v13, v13 row_half_mirror row_mask:0xf bank_mask:0xf
    s_nop 0
    v_cvt_pk_bf16_f32 v15, v12, v13
    v_lshlrev_b32 v12, 16, v15
    v_and_b32 v13, 0xffff0000, v15
    v_max_f32 v14, v12, v13
    s_nop 1
    v_max_f32_dpp v14, v14, v14 row_ror:8 row_mask:0xf bank_mask:0xf
    v_mov_b32 v15, v14
    s_nop 1
    v_permlane16_swap_b32 v14, v15
    s_nop 0
    v_max_f32 v14, v14, v15
    v_mov_b32 v15, v14
    s_nop 1
    v_permlane32_swap_b32 v14, v15
    s_nop 0
    v_max_f32 v14, v14, v15
    v_mul_f32 v14, s72, v14
    v_ceil_f32 v14, v14
    v_max_f32 v14, v14, v8
    v_sub_f32 v15, v8, v14
    v_fma_f32 v12, v12, s72, -v14
    v_fma_f32 v13, v13, s72, -v14
    v_exp_f32 v15, v15
    v_exp_f32 v12, v12
    v_exp_f32 v13, v13
    v_mov_b32 v8, v14
    v_fma_f32 v9, v9, v15, v12
    v_cvt_pk_bf16_f32 v12, v12, v12
    v_add_f32 v9, v9, v13
    v_cvt_pk_bf16_f32 v13, v13, v13
    v_mul_f32 v24, v24, v15
    v_mul_f32 v25, v25, v15
    v_mul_f32 v26, v26, v15
    v_mul_f32 v27, v27, v15
    v_mul_f32 v28, v28, v15
    v_mul_f32 v29, v29, v15
    v_mul_f32 v30, v30, v15
    v_mul_f32 v31, v31, v15
    v_and_b32 v16, v12, v4
    v_and_b32 v17, v12, v5
    v_and_b32 v18, v12, v6
    v_and_b32 v19, v12, v7
    v_and_b32_dpp v20, v12, v4 row_ror:8 row_mask:0xf bank_mask:0xf
    v_and_b32_dpp v21, v12, v5 row_ror:8 row_mask:0xf bank_mask:0xf
    v_and_b32_dpp v22, v12, v6 row_ror:8 row_mask:0xf bank_mask:0xf
    v_and_b32_dpp v23, v12, v7 row_ror:8 row_mask:0xf bank_mask:0xf
    v_mfma_f32_16x16x32_bf16 v[24:27], a[160:163], v[16:19], v[24:27]
    v_mfma_f32_16x16x32_bf16 v[28:31], a[164:167], v[16:19], v[28:31]
    v_mfma_f32_16x16x32_bf16 v[24:27], a[168:171], v[20:23], v[24:27]
    v_mfma_f32_16x16x32_bf16 v[28:31], a[172:175], v[20:23], v[28:31]
    v_and_b32 v16, v13, v4
    v_and_b32 v17, v13, v5
    v_and_b32 v18, v13, v6
    v_and_b32 v19, v13, v7
    v_and_b32_dpp v20, v13, v4 row_ror:8 row_mask:0xf bank_mask:0xf
    v_and_b32_dpp v21, v13, v5 row_ror:8 row_mask:0xf bank_mask:0xf
    v_and_b32_dpp v22, v13, v6 row_ror:8 row_mask:0xf bank_mask:0xf
    v_and_b32_dpp v23, v13, v7 row_ror:8 row_mask:0xf bank_mask:0xf
    v_mfma_f32_16x16x32_bf16 v[24:27], a[176:179], v[16:19], v[24:27]
    v_mfma_f32_16x16x32_bf16 v[28:31], a[180:183], v[16:19], v[28:31]
    v_mfma_f32_16x16x32_bf16 v[24:27], a[184:187], v[20:23], v[24:27]
    v_mfma_f32_16x16x32_bf16 v[28:31], a[188:191], v[20:23], v[28:31]
    s_cmp_lg_u32 s81, 2
    s_cbranch_scc1 L_NORB5
    s_add_u32 s74, s75, 3932160
    s_add_u32 m0, s78, 32768
    s_nop 0
    buffer_load_dwordx4 v1, s[40:43], s74 offen offset:0 nt lds
    s_add_u32 m0, s78, 33664
    s_nop 0
    buffer_load_dwordx4 v1, s[40:43], s74 offen offset:128 nt lds
    s_add_u32 m0, s78, 34560
    s_nop 0
    buffer_load_dwordx4 v1, s[40:43], s74 offen offset:256 nt lds
    s_add_u32 m0, s78, 35456
    s_nop 0
    buffer_load_dwordx4 v1, s[40:43], s74 offen offset:384 nt lds
    s_add_u32 s74, s75, 3932160
    buffer_load_dwordx4 v[48:51], v2, s[44:47], s74 offen offset:0 nt
    buffer_load_dwordx4 v[52:55], v2, s[44:47], s74 offen offset:256 nt
    buffer_load_dwordx4 v[56:59], v2, s[44:47], s74 offen offset:512 nt
    buffer_load_dwordx4 v[60:63], v2, s[44:47], s74 offen offset:768 nt
L_NORB5:
    s_nop 2
    s_cmp_lg_u32 s81, 2
    s_cbranch_scc1 L_NOWT6
    s_waitcnt vmcnt(24)
L_NOWT6:
    v_lshl_add_u32 v13, v0, 4, s78
    ds_read_b128 v[16:19], v13 offset:16384
    ds_read_b128 v[20:23], v13 offset:17408
    s_waitcnt lgkmcnt(1)
    v_dot2_f32_bf16 v14, v16, v32, 0
    v_dot2_f32_bf16 v14, v17, v33, v14
    v_dot2_f32_bf16 v14, v18, v34, v14
    v_dot2_f32_bf16 v14, v19, v35, v14
    ds_read_b128 v[16:19], v13 offset:18432
    s_waitcnt lgkmcnt(1)
    v_dot2_f32_bf16 v15, v20, v36, 0
    v_dot2_f32_bf16 v15, v21, v37, v15
    v_dot2_f32_bf16 v15, v22, v38, v15
    v_dot2_f32_bf16 v15, v23, v39, v15
    ds_read_b128 v[20:23], v13 offset:19456
    s_waitcnt lgkmcnt(1)
    v_dot2_f32_bf16 v14, v16, v40, v14
    v_dot2_f32_bf16 v14, v17, v41, v14
    v_dot2_f32_bf16 v14, v18, v42, v14
    v_dot2_f32_bf16 v14, v19, v43, v14
    s_waitcnt lgkmcnt(0)
    v_dot2_f32_bf16 v15, v20, v44, v15
    v_dot2_f32_bf16 v15, v21, v45, v15
    v_dot2_f32_bf16 v15, v22, v46, v15
    v_dot2_f32_bf16 v15, v23, v47, v15
    s_nop 2
    v_add_f32 v12, v14, v15
    ds_read_b128 v[16:19], v13 offset:20480
    ds_read_b128 v[20:23], v13 offset:21504
    s_waitcnt lgkmcnt(1)
    v_dot2_f32_bf16 v14, v16, v32, 0
    v_dot2_f32_bf16 v14, v17, v33, v14
    v_dot2_f32_bf16 v14, v18, v34, v14
    v_dot2_f32_bf16 v14, v19, v35, v14
    ds_read_b128 v[16:19], v13 offset:22528
    s_waitcnt lgkmcnt(1)
    v_dot2_f32_bf16 v15, v20, v36, 0
    v_dot2_f32_bf16 v15, v21, v37, v15
    v_dot2_f32_bf16 v15, v22, v38, v15
    v_dot2_f32_bf16 v15, v23, v39, v15
    ds_read_b128 v[20:23], v13 offset:23552
    s_waitcnt lgkmcnt(1)
    v_dot2_f32_bf16 v14, v16, v40, v14
    v_dot2_f32_bf16 v14, v17, v41, v14
    v_dot2_f32_bf16 v14, v18, v42, v14
    v_dot2_f32_bf16 v14, v19, v43, v14
    s_waitcnt lgkmcnt(0)
    v_dot2_f32_bf16 v15, v20, v44, v15
    v_dot2_f32_bf16 v15, v21, v45, v15
    v_dot2_f32_bf16 v15, v22, v46, v15
    v_dot2_f32_bf16 v15, v23, v47, v15
    s_nop 2
    v_add_f32 v13, v14, v15
    s_nop 0
    v_add_f32_dpp v12, v12, v12 quad_perm:[1,0,3,2] row_mask:0xf bank_mask:0xf
    v_add_f32_dpp v13, v13, v13 quad_perm:[1,0,3,2] row_mask:0xf bank_mask:0xf
    s_nop 0
    s_nop 0
    v_add_f32_dpp v12, v12, v12 quad_perm:[2,3,0,1] row_mask:0xf bank_mask:0xf
    v_add_f32_dpp v13, v13, v13 quad_perm:[2,3,0,1] row_mask:0xf bank_mask:0xf
    s_nop 0
    s_nop 0
    v_add_f32_dpp v12, v12, v12 row_half_mirror row_mask:0xf bank_mask:0xf
    v_add_f32_dpp v13, v13, v13 row_half_mirror row_mask:0xf bank_mask:0xf
    s_nop 0
    v_cvt_pk_bf16_f32 v15, v12, v13
    v_lshlrev_b32 v12, 16, v15
    v_and_b32 v13, 0xffff0000, v15
    v_max_f32 v14, v12, v13
    s_nop 1
    v_max_f32_dpp v14, v14, v14 row_ror:8 row_mask:0xf bank_mask:0xf
    v_mov_b32 v15, v14
    s_nop 1
    v_permlane16_swap_b32 v14, v15
    s_nop 0
    v_max_f32 v14, v14, v15
    v_mov_b32 v15, v14
    s_nop 1
    v_permlane32_swap_b32 v14, v15
    s_nop 0
    v_max_f32 v14, v14, v15
    v_mul_f32 v14, s72, v14
    v_ceil_f32 v14, v14
    v_max_f32 v14, v14, v8
    v_sub_f32 v15, v8, v14
    v_fma_f32 v12, v12, s72, -v14
    v_fma_f32 v13, v13, s72, -v14
    v_exp_f32 v15, v15
    v_exp_f32 v12, v12
    v_exp_f32 v13, v13
    v_mov_b32 v8, v14
    v_fma_f32 v9, v9, v15, v12
    v_cvt_pk_bf16_f32 v12, v12, v12
    v_add_f32 v9, v9, v13
    v_cvt_pk_bf16_f32 v13, v13, v13
    v_mul_f32 v24, v24, v15
    v_mul_f32 v25, v25, v15
    v_mul_f32 v26, v26, v15
    v_mul_f32 v27, v27, v15
    v_mul_f32 v28, v28, v15
    v_mul_f32 v29, v29, v15
    v_mul_f32 v30, v30, v15
    v_mul_f32 v31, v31, v15
    v_and_b32 v16, v12, v4
    v_and_b32 v17, v12, v5
    v_and_b32 v18, v12, v6
    v_and_b32 v19, v12, v7
    v_and_b32_dpp v20, v12, v4 row_ror:8 row_mask:0xf bank_mask:0xf
    v_and_b32_dpp v21, v12, v5 row_ror:8 row_mask:0xf bank_mask:0xf
    v_and_b32_dpp v22, v12, v6 row_ror:8 row_mask:0xf bank_mask:0xf
    v_and_b32_dpp v23, v12, v7 row_ror:8 row_mask:0xf bank_mask:0xf
    v_mfma_f32_16x16x32_bf16 v[24:27], a[192:195], v[16:19], v[24:27]
    v_mfma_f32_16x16x32_bf16 v[28:31], a[196:199], v[16:19], v[28:31]
    v_mfma_f32_16x16x32_bf16 v[24:27], a[200:203], v[20:23], v[24:27]
    v_mfma_f32_16x16x32_bf16 v[28:31], a[204:207], v[20:23], v[28:31]
    v_and_b32 v16, v13, v4
    v_and_b32 v17, v13, v5
    v_and_b32 v18, v13, v6
    v_and_b32 v19, v13, v7
    v_and_b32_dpp v20, v13, v4 row_ror:8 row_mask:0xf bank_mask:0xf
    v_and_b32_dpp v21, v13, v5 row_ror:8 row_mask:0xf bank_mask:0xf
    v_and_b32_dpp v22, v13, v6 row_ror:8 row_mask:0xf bank_mask:0xf
    v_and_b32_dpp v23, v13, v7 row_ror:8 row_mask:0xf bank_mask:0xf
    v_mfma_f32_16x16x32_bf16 v[24:27], a[208:211], v[16:19], v[24:27]
    v_mfma_f32_16x16x32_bf16 v[28:31], a[212:215], v[16:19], v[28:31]
    v_mfma_f32_16x16x32_bf16 v[24:27], a[216:219], v[20:23], v[24:27]
    v_mfma_f32_16x16x32_bf16 v[28:31], a[220:223], v[20:23], v[28:31]
    s_nop 2
    s_cmp_lg_u32 s81, 2
    s_cbranch_scc1 L_NOWT7
    s_waitcnt vmcnt(8)
L_NOWT7:
    v_lshl_add_u32 v13, v0, 4, s78
    ds_read_b128 v[16:19], v13 offset:24576
    ds_read_b128 v[20:23], v13 offset:25600
    s_waitcnt lgkmcnt(1)
    v_dot2_f32_bf16 v14, v16, v32, 0
    v_dot2_f32_bf16 v14, v17, v33, v14
    v_dot2_f32_bf16 v14, v18, v34, v14
    v_dot2_f32_bf16 v14, v19, v35, v14
    ds_read_b128 v[16:19], v13 offset:26624
    s_waitcnt lgkmcnt(1)
    v_dot2_f32_bf16 v15, v20, v36, 0
    v_dot2_f32_bf16 v15, v21, v37, v15
    v_dot2_f32_bf16 v15, v22, v38, v15
    v_dot2_f32_bf16 v15, v23, v39, v15
    ds_read_b128 v[20:23], v13 offset:27648
    s_waitcnt lgkmcnt(1)
    v_dot2_f32_bf16 v14, v16, v40, v14
    v_dot2_f32_bf16 v14, v17, v41, v14
    v_dot2_f32_bf16 v14, v18, v42, v14
    v_dot2_f32_bf16 v14, v19, v43, v14
    s_waitcnt lgkmcnt(0)
    v_dot2_f32_bf16 v15, v20, v44, v15
    v_dot2_f32_bf16 v15, v21, v45, v15
    v_dot2_f32_bf16 v15, v22, v46, v15
    v_dot2_f32_bf16 v15, v23, v47, v15
    s_nop 2
    v_add_f32 v12, v14, v15
    ds_read_b128 v[16:19], v13 offset:28672
    ds_read_b128 v[20:23], v13 offset:29696
    s_waitcnt lgkmcnt(1)
    v_dot2_f32_bf16 v14, v16, v32, 0
    v_dot2_f32_bf16 v14, v17, v33, v14
    v_dot2_f32_bf16 v14, v18, v34, v14
    v_dot2_f32_bf16 v14, v19, v35, v14
    ds_read_b128 v[16:19], v13 offset:30720
    s_waitcnt lgkmcnt(1)
    v_dot2_f32_bf16 v15, v20, v36, 0
    v_dot2_f32_bf16 v15, v21, v37, v15
    v_dot2_f32_bf16 v15, v22, v38, v15
    v_dot2_f32_bf16 v15, v23, v39, v15
    ds_read_b128 v[20:23], v13 offset:31744
    s_waitcnt lgkmcnt(1)
    v_dot2_f32_bf16 v14, v16, v40, v14
    v_dot2_f32_bf16 v14, v17, v41, v14
    v_dot2_f32_bf16 v14, v18, v42, v14
    v_dot2_f32_bf16 v14, v19, v43, v14
    s_waitcnt lgkmcnt(0)
    v_dot2_f32_bf16 v15, v20, v44, v15
    v_dot2_f32_bf16 v15, v21, v45, v15
    v_dot2_f32_bf16 v15, v22, v46, v15
    v_dot2_f32_bf16 v15, v23, v47, v15
    s_nop 2
    v_add_f32 v13, v14, v15
    s_nop 0
    v_add_f32_dpp v12, v12, v12 quad_perm:[1,0,3,2] row_mask:0xf bank_mask:0xf
    v_add_f32_dpp v13, v13, v13 quad_perm:[1,0,3,2] row_mask:0xf bank_mask:0xf
    s_nop 0
    s_nop 0
    v_add_f32_dpp v12, v12, v12 quad_perm:[2,3,0,1] row_mask:0xf bank_mask:0xf
    v_add_f32_dpp v13, v13, v13 quad_perm:[2,3,0,1] row_mask:0xf bank_mask:0xf
    s_nop 0
    s_nop 0
    v_add_f32_dpp v12, v12, v12 row_half_mirror row_mask:0xf bank_mask:0xf
    v_add_f32_dpp v13, v13, v13 row_half_mirror row_mask:0xf bank_mask:0xf
    s_nop 0
    v_cvt_pk_bf16_f32 v15, v12, v13
    v_lshlrev_b32 v12, 16, v15
    v_and_b32 v13, 0xffff0000, v15
    v_max_f32 v14, v12, v13
    s_nop 1
    v_max_f32_dpp v14, v14, v14 row_ror:8 row_mask:0xf bank_mask:0xf
    v_mov_b32 v15, v14
    s_nop 1
    v_permlane16_swap_b32 v14, v15
    s_nop 0
    v_max_f32 v14, v14, v15
    v_mov_b32 v15, v14
    s_nop 1
    v_permlane32_swap_b32 v14, v15
    s_nop 0
    v_max_f32 v14, v14, v15
    v_mul_f32 v14, s72, v14
    v_ceil_f32 v14, v14
    v_max_f32 v14, v14, v8
    v_sub_f32 v15, v8, v14
    v_fma_f32 v12, v12, s72, -v14
    v_fma_f32 v13, v13, s72, -v14
    v_exp_f32 v15, v15
    v_exp_f32 v12, v12
    v_exp_f32 v13, v13
    v_mov_b32 v8, v14
    v_fma_f32 v9, v9, v15, v12
    v_cvt_pk_bf16_f32 v12, v12, v12
    v_add_f32 v9, v9, v13
    v_cvt_pk_bf16_f32 v13, v13, v13
    v_mul_f32 v24, v24, v15
    v_mul_f32 v25, v25, v15
    v_mul_f32 v26, v26, v15
    v_mul_f32 v27, v27, v15
    v_mul_f32 v28, v28, v15
    v_mul_f32 v29, v29, v15
    v_mul_f32 v30, v30, v15
    v_mul_f32 v31, v31, v15
    v_and_b32 v16, v12, v4
    v_and_b32 v17, v12, v5
    v_and_b32 v18, v12, v6
    v_and_b32 v19, v12, v7
    v_and_b32_dpp v20, v12, v4 row_ror:8 row_mask:0xf bank_mask:0xf
    v_and_b32_dpp v21, v12, v5 row_ror:8 row_mask:0xf bank_mask:0xf
    v_and_b32_dpp v22, v12, v6 row_ror:8 row_mask:0xf bank_mask:0xf
    v_and_b32_dpp v23, v12, v7 row_ror:8 row_mask:0xf bank_mask:0xf
    v_mfma_f32_16x16x32_bf16 v[24:27], a[224:227], v[16:19], v[24:27]
    v_mfma_f32_16x16x32_bf16 v[28:31], a[228:231], v[16:19], v[28:31]
    v_mfma_f32_16x16x32_bf16 v[24:27], a[232:235], v[20:23], v[24:27]
    v_mfma_f32_16x16x32_bf16 v[28:31], a[236:239], v[20:23], v[28:31]
    v_and_b32 v16, v13, v4
    v_and_b32 v17, v13, v5
    v_and_b32 v18, v13, v6
    v_and_b32 v19, v13, v7
    v_and_b32_dpp v20, v13, v4 row_ror:8 row_mask:0xf bank_mask:0xf
    v_and_b32_dpp v21, v13, v5 row_ror:8 row_mask:0xf bank_mask:0xf
    v_and_b32_dpp v22, v13, v6 row_ror:8 row_mask:0xf bank_mask:0xf
    v_and_b32_dpp v23, v13, v7 row_ror:8 row_mask:0xf bank_mask:0xf
    v_mfma_f32_16x16x32_bf16 v[24:27], a[240:243], v[16:19], v[24:27]
    v_mfma_f32_16x16x32_bf16 v[28:31], a[244:247], v[16:19], v[28:31]
    v_mfma_f32_16x16x32_bf16 v[24:27], a[248:251], v[20:23], v[24:27]
    v_mfma_f32_16x16x32_bf16 v[28:31], a[252:255], v[20:23], v[28:31]
    s_nop 2
    s_cmp_lg_u32 s81, 2
    s_cbranch_scc1 L_NOWT8
    s_waitcnt vmcnt(0)
L_NOWT8:
    v_lshl_add_u32 v13, v0, 4, s78
    ds_read_b128 v[16:19], v13 offset:32768
    ds_read_b128 v[20:23], v13 offset:33792
    s_waitcnt lgkmcnt(1)
    v_dot2_f32_bf16 v14, v16, v32, 0
    v_dot2_f32_bf16 v14, v17, v33, v14
    v_dot2_f32_bf16 v14, v18, v34, v14
    v_dot2_f32_bf16 v14, v19, v35, v14
    ds_read_b128 v[16:19], v13 offset:34816
    s_waitcnt lgkmcnt(1)
    v_dot2_f32_bf16 v15, v20, v36, 0
    v_dot2_f32_bf16 v15, v21, v37, v15
    v_dot2_f32_bf16 v15, v22, v38, v15
    v_dot2_f32_bf16 v15, v23, v39, v15
    ds_read_b128 v[20:23], v13 offset:35840
    s_waitcnt lgkmcnt(1)
    v_dot2_f32_bf16 v14, v16, v40, v14
    v_dot2_f32_bf16 v14, v17, v41, v14
    v_dot2_f32_bf16 v14, v18, v42, v14
    v_dot2_f32_bf16 v14, v19, v43, v14
    s_waitcnt lgkmcnt(0)
    v_dot2_f32_bf16 v15, v20, v44, v15
    v_dot2_f32_bf16 v15, v21, v45, v15
    v_dot2_f32_bf16 v15, v22, v46, v15
    v_dot2_f32_bf16 v15, v23, v47, v15
    s_nop 2
    v_add_f32 v12, v14, v15
    v_mov_b32 v13, 0xf149f2ca
    s_nop 0
    v_add_f32_dpp v12, v12, v12 quad_perm:[1,0,3,2] row_mask:0xf bank_mask:0xf
    v_add_f32_dpp v13, v13, v13 quad_perm:[1,0,3,2] row_mask:0xf bank_mask:0xf
    s_nop 0
    s_nop 0
    v_add_f32_dpp v12, v12, v12 quad_perm:[2,3,0,1] row_mask:0xf bank_mask:0xf
    v_add_f32_dpp v13, v13, v13 quad_perm:[2,3,0,1] row_mask:0xf bank_mask:0xf
    s_nop 0
    s_nop 0
    v_add_f32_dpp v12, v12, v12 row_half_mirror row_mask:0xf bank_mask:0xf
    v_add_f32_dpp v13, v13, v13 row_half_mirror row_mask:0xf bank_mask:0xf
    s_nop 0
    v_cvt_pk_bf16_f32 v15, v12, v13
    v_lshlrev_b32 v12, 16, v15
    v_and_b32 v13, 0xffff0000, v15
    v_max_f32 v14, v12, v13
    s_nop 1
    v_max_f32_dpp v14, v14, v14 row_ror:8 row_mask:0xf bank_mask:0xf
    v_mov_b32 v15, v14
    s_nop 1
    v_permlane16_swap_b32 v14, v15
    s_nop 0
    v_max_f32 v14, v14, v15
    v_mov_b32 v15, v14
    s_nop 1
    v_permlane32_swap_b32 v14, v15
    s_nop 0
    v_max_f32 v14, v14, v15
    v_mul_f32 v14, s72, v14
    v_ceil_f32 v14, v14
    v_max_f32 v14, v14, v8
    v_sub_f32 v15, v8, v14
    v_fma_f32 v12, v12, s72, -v14
    v_fma_f32 v13, v13, s72, -v14
    v_exp_f32 v15, v15
    v_exp_f32 v12, v12
    v_exp_f32 v13, v13
    v_mov_b32 v8, v14
    v_fma_f32 v9, v9, v15, v12
    v_cvt_pk_bf16_f32 v12, v12, v12
    v_add_f32 v9, v9, v13
    v_cvt_pk_bf16_f32 v13, v13, v13
    v_mul_f32 v24, v24, v15
    v_mul_f32 v25, v25, v15
    v_mul_f32 v26, v26, v15
    v_mul_f32 v27, v27, v15
    v_mul_f32 v28, v28, v15
    v_mul_f32 v29, v29, v15
    v_mul_f32 v30, v30, v15
    v_mul_f32 v31, v31, v15
    v_and_b32 v16, v12, v4
    v_and_b32 v17, v12, v5
    v_and_b32 v18, v12, v6
    v_and_b32 v19, v12, v7
    v_and_b32_dpp v20, v12, v4 row_ror:8 row_mask:0xf bank_mask:0xf
    v_and_b32_dpp v21, v12, v5 row_ror:8 row_mask:0xf bank_mask:0xf
    v_and_b32_dpp v22, v12, v6 row_ror:8 row_mask:0xf bank_mask:0xf
    v_and_b32_dpp v23, v12, v7 row_ror:8 row_mask:0xf bank_mask:0xf
    v_mfma_f32_16x16x32_bf16 v[24:27], v[48:51], v[16:19], v[24:27]
    v_mfma_f32_16x16x32_bf16 v[28:31], v[52:55], v[16:19], v[28:31]
    v_mfma_f32_16x16x32_bf16 v[24:27], v[56:59], v[20:23], v[24:27]
    v_mfma_f32_16x16x32_bf16 v[28:31], v[60:63], v[20:23], v[28:31]
    s_nop 2
    s_mov_b32 s77, 0
    s_cmp_eq_u32 s79, 0
    s_cbranch_scc1 L_LOOP
    s_cmp_eq_u32 s79, 2
    s_cbranch_scc1 L_AFTER2
    s_cmp_eq_u32 s79, 3
    s_cbranch_scc1 L_AFTER3
L_SWITCH:
    s_cmp_eq_u32 s77, 0
    s_cbranch_scc1 L_SW1
    s_mov_b32 s79, 1
    s_waitcnt vmcnt(0)
    s_branch L_DOSTAT
L_SW1:
    s_cmp_lg_u32 s13, 1
    s_cbranch_scc1 L_SW2
    s_mov_b32 s15, 151680
    s_mul_i32 s74, s3, 1056
    s_add_u32 s74, s74, s15
    v_lshrrev_b32 v12, 4, v0
    v_and_b32 v13, 15, v0
    v_lshl_add_u32 v12, v12, 3, v13
    v_lshl_add_u32 v14, v12, 4, s74
    s_nop 1
    v_add_f32_dpp v9, v9, v9 row_ror:8 row_mask:0xf bank_mask:0xf
    v_mov_b32 v15, v9
    s_nop 1
    v_permlane16_swap_b32 v9, v15
    s_nop 0
    v_add_f32 v9, v9, v15
    v_mov_b32 v15, v9
    s_nop 1
    v_permlane32_swap_b32 v9, v15
    s_nop 0
    v_add_f32 v9, v9, v15
    s_mov_b32 exec_lo, 0xff00ff
    s_mov_b32 exec_hi, 0xff00ff
    ds_write_b128 v14, v[24:27]
    ds_write_b128 v14, v[28:31] offset:512
    s_mov_b64 exec, 1
    ds_write_b64 v14, v[8:9] offset:1024
    s_mov_b64 exec, -1
    s_branch L_SW3
L_SW2:
    s_and_b32 s15, s13, 1
    s_mul_i32 s15, s15, 4224
    s_add_u32 s15, s15, 147456
    s_mul_i32 s74, s3, 1056
    s_add_u32 s74, s74, s15
    v_lshrrev_b32 v12, 4, v0
    v_and_b32 v13, 15, v0
    v_lshl_add_u32 v12, v12, 3, v13
    v_lshl_add_u32 v14, v12, 4, s74
    s_nop 1
    v_add_f32_dpp v9, v9, v9 row_ror:8 row_mask:0xf bank_mask:0xf
    v_mov_b32 v15, v9
    s_nop 1
    v_permlane16_swap_b32 v9, v15
    s_nop 0
    v_add_f32 v9, v9, v15
    v_mov_b32 v15, v9
    s_nop 1
    v_permlane32_swap_b32 v9, v15
    s_nop 0
    v_add_f32 v9, v9, v15
    s_mov_b32 exec_lo, 0xff00ff
    s_mov_b32 exec_hi, 0xff00ff
    ds_write_b128 v14, v[24:27]
    ds_write_b128 v14, v[28:31] offset:512
    s_mov_b64 exec, 1
    ds_write_b64 v14, v[8:9] offset:1024
    s_mov_b64 exec, -1
    s_lshl_b32 s74, s13, 2
    s_add_u32 s74, s74, 155904
    s_mov_b64 exec, 1
    v_mov_b32 v14, s74
    v_mov_b32 v15, 1
    s_waitcnt lgkmcnt(0)
    ds_add_rtn_u32 v15, v14, v15
    s_waitcnt lgkmcnt(0)
    v_readfirstlane_b32 s74, v15
    s_mov_b64 exec, -1
    s_nop 1
    s_cmp_lg_u32 s74, 3
    s_cbranch_scc1 L_NOPUB0
    v_mov_b32 v14, s15
    v_lshl_add_u32 v15, v0, 4, s15
    ds_read_b64 v[16:17], v14 offset:1024
    ds_read_b64 v[18:19], v14 offset:2080
    ds_read_b64 v[20:21], v14 offset:3136
    ds_read_b64 v[22:23], v14 offset:4192
    ds_read_b128 v[32:35], v15 offset:0
    ds_read_b128 v[36:39], v15 offset:1056
    ds_read_b128 v[40:43], v15 offset:2112
    ds_read_b128 v[44:47], v15 offset:3168
    s_mul_i32 s15, s13, 15
    s_add_u32 s15, s15, s5
    s_mul_i32 s15, s15, 1152
    s_add_u32 s15, s15, s73
    s_add_u32 s15, s15, 16640
    v_lshlrev_b32 v12, 4, v0
    s_waitcnt lgkmcnt(4)
    v_max3_f32 v8, v16, v18, v20
    v_max_f32 v8, v8, v22
    v_sub_f32 v16, v16, v8
    v_sub_f32 v18, v18, v8
    v_sub_f32 v20, v20, v8
    v_sub_f32 v22, v22, v8
    v_exp_f32 v16, v16
    v_exp_f32 v18, v18
    v_exp_f32 v20, v20
    v_exp_f32 v22, v22
    s_nop 0
    v_mul_f32 v9, v16, v17
    v_fmac_f32 v9, v18, v19
    v_fmac_f32 v9, v20, v21
    v_fmac_f32 v9, v22, v23
    s_waitcnt lgkmcnt(0)
    v_mul_f32 v24, v16, v32
    v_mul_f32 v25, v16, v33
    v_mul_f32 v26, v16, v34
    v_mul_f32 v27, v16, v35
    v_fmac_f32 v24, v18, v36
    v_fmac_f32 v25, v18, v37
    v_fmac_f32 v26, v18, v38
    v_fmac_f32 v27, v18, v39
    v_fmac_f32 v24, v20, v40
    v_fmac_f32 v25, v20, v41
    v_fmac_f32 v26, v20, v42
    v_fmac_f32 v27, v20, v43
    v_fmac_f32 v24, v22, v44
    v_fmac_f32 v25, v22, v45
    v_fmac_f32 v26, v22, v46
    v_fmac_f32 v27, v22, v47
    v_min_u32 v24, -2, v24
    v_min_u32 v25, -2, v25
    v_min_u32 v26, -2, v26
    v_min_u32 v27, -2, v27
    v_min_u32 v8, -2, v8
    v_min_u32 v9, -2, v9
    buffer_store_dwordx4 v[24:27], v12, s[48:51], s15 offen sc1
    s_mov_b64 exec, 1
    buffer_store_dwordx2 v[8:9], off, s[48:51], s15 offset:1024 sc1
    s_mov_b64 exec, -1
    s_nop 1
L_NOPUB0:
L_SW3:
    s_add_u32 s13, s13, 1
    s_cmp_ge_u32 s13, 4
    s_cbranch_scc1 L_END
L_SETUP:
    s_cmp_eq_u32 s14, s13
    s_cbranch_scc1 L_QCHK
L_QSLOW:
    s_mov_b32 s14, -1
    s_lshl_b32 s74, s13, 9
    s_add_u32 s74, s74, s73
    v_lshlrev_b32 v14, 3, v0
    buffer_load_dwordx2 v[10:11], v14, s[48:51], s74 offen offset:256 sc1
    s_waitcnt vmcnt(0)
L_QCHK:
    v_max_u32 v14, v10, v11
    v_cmp_eq_u32 vcc, -1, v14
    s_cbranch_vccz L_QOK
    s_sleep 2
    s_sub_u32 s96, s96, 1
    s_cmp_eq_u32 s96, 0
    s_cbranch_scc1 L_END
    s_branch L_QSLOW
L_QOK:
    s_lshl_b32 s74, s3, 10
    s_and_b32 s15, s13, 1
    s_lshl_b32 s15, s15, 9
    s_add_u32 s74, s74, s15
    s_add_u32 s74, s74, 156160
    v_lshl_add_u32 v12, v0, 3, s74
    ds_write_b64 v12, v[10:11]
    v_and_b32 v13, 7, v0
    v_lshl_add_u32 v13, v13, 4, s74
    s_waitcnt lgkmcnt(0)
    ds_read_b128 v[32:35], v13 offset:0
    ds_read_b128 v[36:39], v13 offset:128
    ds_read_b128 v[40:43], v13 offset:256
    ds_read_b128 v[44:47], v13 offset:384
    v_mov_b32 v24, 0
    v_mov_b32 v25, 0
    v_mov_b32 v26, 0
    v_mov_b32 v27, 0
    v_mov_b32 v28, 0
    v_mov_b32 v29, 0
    v_mov_b32 v30, 0
    v_mov_b32 v31, 0
    v_mov_b32 v9, 0
    v_mov_b32 v8, 0xf149f2ca
    s_waitcnt lgkmcnt(0)
    s_cmp_lg_u32 s13, 1
    s_cselect_b32 s77, 1, 0
    s_cmp_lg_u32 s13, 2
    s_cbranch_scc1 L_SW4
    s_mov_b32 s81, 1
    s_mov_b32 s79, 2
    s_branch L_DOSTAT
L_AFTER2:
    s_mov_b32 s15, 147456
    s_mul_i32 s74, s3, 1056
    s_add_u32 s74, s74, s15
    v_lshrrev_b32 v12, 4, v0
    v_and_b32 v13, 15, v0
    v_lshl_add_u32 v12, v12, 3, v13
    v_lshl_add_u32 v14, v12, 4, s74
    s_nop 1
    v_add_f32_dpp v9, v9, v9 row_ror:8 row_mask:0xf bank_mask:0xf
    v_mov_b32 v15, v9
    s_nop 1
    v_permlane16_swap_b32 v9, v15
    s_nop 0
    v_add_f32 v9, v9, v15
    v_mov_b32 v15, v9
    s_nop 1
    v_permlane32_swap_b32 v9, v15
    s_nop 0
    v_add_f32 v9, v9, v15
    s_mov_b32 exec_lo, 0xff00ff
    s_mov_b32 exec_hi, 0xff00ff
    ds_write_b128 v14, v[24:27]
    ds_write_b128 v14, v[28:31] offset:512
    s_mov_b64 exec, 1
    ds_write_b64 v14, v[8:9] offset:1024
    s_mov_b64 exec, -1
    s_lshl_b32 s74, s3, 10
    s_add_u32 s74, s74, 156672
    v_and_b32 v13, 7, v0
    v_lshl_add_u32 v13, v13, 4, s74
    s_waitcnt lgkmcnt(0)
    ds_read_b128 v[32:35], v13 offset:0
    ds_read_b128 v[36:39], v13 offset:128
    ds_read_b128 v[40:43], v13 offset:256
    ds_read_b128 v[44:47], v13 offset:384
    s_mov_b32 s15, 151680
    s_mul_i32 s74, s3, 1056
    s_add_u32 s74, s74, s15
    v_lshrrev_b32 v12, 4, v0
    v_and_b32 v13, 15, v0
    v_lshl_add_u32 v12, v12, 3, v13
    v_lshl_add_u32 v14, v12, 4, s74
    v_mov_b32 v15, s74
    v_mov_b32 v24, 0
    v_mov_b32 v25, 0
    v_mov_b32 v26, 0
    v_mov_b32 v27, 0
    v_mov_b32 v28, 0
    v_mov_b32 v29, 0
    v_mov_b32 v30, 0
    v_mov_b32 v31, 0
    ds_read_b64 v[8:9], v15 offset:1024
    s_mov_b32 exec_lo, 0xff00ff
    s_mov_b32 exec_hi, 0xff00ff
    ds_read_b128 v[24:27], v14
    ds_read_b128 v[28:31], v14 offset:512
    s_mov_b64 exec, -1
    s_waitcnt lgkmcnt(0)
    v_mul_f32 v9, 0x3e000000, v9
    s_mov_b32 s81, 2
    s_mov_b32 s79, 3
    s_branch L_DOSTAT
L_AFTER3:
    s_mov_b32 s81, 0
    s_mov_b32 s15, 151680
    s_mul_i32 s74, s3, 1056
    s_add_u32 s74, s74, s15
    v_lshrrev_b32 v12, 4, v0
    v_and_b32 v13, 15, v0
    v_lshl_add_u32 v12, v12, 3, v13
    v_lshl_add_u32 v14, v12, 4, s74
    s_nop 1
    v_add_f32_dpp v9, v9, v9 row_ror:8 row_mask:0xf bank_mask:0xf
    v_mov_b32 v15, v9
    s_nop 1
    v_permlane16_swap_b32 v9, v15
    s_nop 0
    v_add_f32 v9, v9, v15
    v_mov_b32 v15, v9
    s_nop 1
    v_permlane32_swap_b32 v9, v15
    s_nop 0
    v_add_f32 v9, v9, v15
    s_mov_b32 exec_lo, 0xff00ff
    s_mov_b32 exec_hi, 0xff00ff
    ds_write_b128 v14, v[24:27]
    ds_write_b128 v14, v[28:31] offset:512
    s_mov_b64 exec, 1
    ds_write_b64 v14, v[8:9] offset:1024
    s_mov_b64 exec, -1
    s_mov_b32 s74, 155908
    s_mov_b64 exec, 1
    v_mov_b32 v14, s74
    v_mov_b32 v15, 1
    s_waitcnt lgkmcnt(0)
    ds_add_rtn_u32 v15, v14, v15
    s_waitcnt lgkmcnt(0)
    v_readfirstlane_b32 s74, v15
    s_mov_b64 exec, -1
    s_nop 1
    s_cmp_lg_u32 s74, 3
    s_cbranch_scc1 L_NOPUB1
    v_mov_b32 v14, s15
    v_lshl_add_u32 v15, v0, 4, s15
    ds_read_b64 v[16:17], v14 offset:1024
    ds_read_b64 v[18:19], v14 offset:2080
    ds_read_b64 v[20:21], v14 offset:3136
    ds_read_b64 v[22:23], v14 offset:4192
    ds_read_b128 v[32:35], v15 offset:0
    ds_read_b128 v[36:39], v15 offset:1056
    ds_read_b128 v[40:43], v15 offset:2112
    ds_read_b128 v[44:47], v15 offset:3168
    s_add_u32 s15, s5, 15
    s_mul_i32 s15, s15, 1152
    s_add_u32 s15, s15, s73
    s_add_u32 s15, s15, 16640
    v_lshlrev_b32 v12, 4, v0
    s_waitcnt lgkmcnt(4)
    v_max3_f32 v8, v16, v18, v20
    v_max_f32 v8, v8, v22
    v_sub_f32 v16, v16, v8
    v_sub_f32 v18, v18, v8
    v_sub_f32 v20, v20, v8
    v_sub_f32 v22, v22, v8
    v_exp_f32 v16, v16
    v_exp_f32 v18, v18
    v_exp_f32 v20, v20
    v_exp_f32 v22, v22
    s_nop 0
    v_mul_f32 v9, v16, v17
    v_fmac_f32 v9, v18, v19
    v_fmac_f32 v9, v20, v21
    v_fmac_f32 v9, v22, v23
    s_waitcnt lgkmcnt(0)
    v_mul_f32 v24, v16, v32
    v_mul_f32 v25, v16, v33
    v_mul_f32 v26, v16, v34
    v_mul_f32 v27, v16, v35
    v_fmac_f32 v24, v18, v36
    v_fmac_f32 v25, v18, v37
    v_fmac_f32 v26, v18, v38
    v_fmac_f32 v27, v18, v39
    v_fmac_f32 v24, v20, v40
    v_fmac_f32 v25, v20, v41
    v_fmac_f32 v26, v20, v42
    v_fmac_f32 v27, v20, v43
    v_fmac_f32 v24, v22, v44
    v_fmac_f32 v25, v22, v45
    v_fmac_f32 v26, v22, v46
    v_fmac_f32 v27, v22, v47
    v_min_u32 v24, -2, v24
    v_min_u32 v25, -2, v25
    v_min_u32 v26, -2, v26
    v_min_u32 v27, -2, v27
    v_min_u32 v8, -2, v8
    v_min_u32 v9, -2, v9
    buffer_store_dwordx4 v[24:27], v12, s[48:51], s15 offen sc1
    s_mov_b64 exec, 1
    buffer_store_dwordx2 v[8:9], off, s[48:51], s15 offset:1024 sc1
    s_mov_b64 exec, -1
    s_nop 1
L_NOPUB1:
    s_lshl_b32 s74, s3, 10
    s_add_u32 s74, s74, 156160
    v_and_b32 v13, 7, v0
    v_lshl_add_u32 v13, v13, 4, s74
    s_waitcnt lgkmcnt(0)
    ds_read_b128 v[32:35], v13 offset:0
    ds_read_b128 v[36:39], v13 offset:128
    ds_read_b128 v[40:43], v13 offset:256
    ds_read_b128 v[44:47], v13 offset:384
    s_mov_b32 s15, 147456
    s_mul_i32 s74, s3, 1056
    s_add_u32 s74, s74, s15
    v_lshrrev_b32 v12, 4, v0
    v_and_b32 v13, 15, v0
    v_lshl_add_u32 v12, v12, 3, v13
    v_lshl_add_u32 v14, v12, 4, s74
    v_mov_b32 v15, s74
    v_mov_b32 v24, 0
    v_mov_b32 v25, 0
    v_mov_b32 v26, 0
    v_mov_b32 v27, 0
    v_mov_b32 v28, 0
    v_mov_b32 v29, 0
    v_mov_b32 v30, 0
    v_mov_b32 v31, 0
    ds_read_b64 v[8:9], v15 offset:1024
    s_mov_b32 exec_lo, 0xff00ff
    s_mov_b32 exec_hi, 0xff00ff
    ds_read_b128 v[24:27], v14
    ds_read_b128 v[28:31], v14 offset:512
    s_mov_b64 exec, -1
    s_waitcnt lgkmcnt(0)
    v_mul_f32 v9, 0x3e000000, v9
L_SW4:
    s_cmp_lg_u32 s12, s13
    s_cbranch_scc1 L_SWITCH
    s_branch L_BODY
L_SERVICE:
    s_mov_b32 s40, s16
    s_and_b32 s41, s17, 0xffff
    s_mov_b32 s42, 1792
    s_mov_b32 s43, 0x20000
    s_mov_b32 s44, s22
    s_and_b32 s45, s23, 0xffff
    s_mov_b32 s46, 3670016
    s_mov_b32 s47, 0x20000
    s_mov_b32 s56, s24
    s_and_b32 s57, s25, 0xffff
    s_mov_b32 s58, 3670016
    s_mov_b32 s59, 0x20000
    s_mov_b32 s60, s28
    s_and_b32 s61, s29, 0xffff
    s_mov_b32 s62, 1605632
    s_mov_b32 s63, 0x20000
    s_mov_b32 s64, s30
    s_and_b32 s65, s31, 0xffff
    s_mov_b32 s66, 1605632
    s_mov_b32 s67, 0x20000
    s_mov_b32 s68, s32
    s_and_b32 s69, s33, 0xffff
    s_mov_b32 s70, 1605632
    s_mov_b32 s71, 0x20000
    s_mov_b32 s80, s34
    s_and_b32 s81, s35, 0xffff
    s_mov_b32 s82, 1792
    s_mov_b32 s83, 0x20000
    s_mul_i32 s6, s2, 98304
    s_mov_b32 s12, 0xff00ff00
    s_mov_b32 s13, 0xff00ff00
    v_mov_b32 v40, -1
    v_mov_b32 v41, -1
    v_mov_b32 v42, -1
    v_mov_b32 v43, -1
    v_lshlrev_b32 v19, 4, v0
    s_mul_i32 s8, s3, 21504
    s_add_u32 s8, s8, s6
    s_add_u32 s7, s8, 0
    buffer_store_dwordx4 v[40:43], v19, s[48:51], s7 offen sc1
    s_add_u32 s7, s8, 1024
    buffer_store_dwordx4 v[40:43], v19, s[48:51], s7 offen sc1
    s_add_u32 s7, s8, 2048
    buffer_store_dwordx4 v[40:43], v19, s[48:51], s7 offen sc1
    s_add_u32 s7, s8, 3072
    buffer_store_dwordx4 v[40:43], v19, s[48:51], s7 offen sc1
    s_add_u32 s7, s8, 4096
    buffer_store_dwordx4 v[40:43], v19, s[48:51], s7 offen sc1
    s_add_u32 s7, s8, 5120
    buffer_store_dwordx4 v[40:43], v19, s[48:51], s7 offen sc1
    s_add_u32 s7, s8, 6144
    buffer_store_dwordx4 v[40:43], v19, s[48:51], s7 offen sc1
    s_add_u32 s7, s8, 7168
    buffer_store_dwordx4 v[40:43], v19, s[48:51], s7 offen sc1
    s_add_u32 s7, s8, 8192
    buffer_store_dwordx4 v[40:43], v19, s[48:51], s7 offen sc1
    s_add_u32 s7, s8, 9216
    buffer_store_dwordx4 v[40:43], v19, s[48:51], s7 offen sc1
    s_add_u32 s7, s8, 10240
    buffer_store_dwordx4 v[40:43], v19, s[48:51], s7 offen sc1
    s_add_u32 s7, s8, 11264
    buffer_store_dwordx4 v[40:43], v19, s[48:51], s7 offen sc1
    s_add_u32 s7, s8, 12288
    buffer_store_dwordx4 v[40:43], v19, s[48:51], s7 offen sc1
    s_add_u32 s7, s8, 13312
    buffer_store_dwordx4 v[40:43], v19, s[48:51], s7 offen sc1
    s_add_u32 s7, s8, 14336
    buffer_store_dwordx4 v[40:43], v19, s[48:51], s7 offen sc1
    s_add_u32 s7, s8, 15360
    buffer_store_dwordx4 v[40:43], v19, s[48:51], s7 offen sc1
    s_add_u32 s7, s8, 16384
    buffer_store_dwordx4 v[40:43], v19, s[48:51], s7 offen sc1
    s_add_u32 s7, s8, 17408
    buffer_store_dwordx4 v[40:43], v19, s[48:51], s7 offen sc1
    s_add_u32 s7, s8, 18432
    buffer_store_dwordx4 v[40:43], v19, s[48:51], s7 offen sc1
    s_add_u32 s7, s8, 19456
    buffer_store_dwordx4 v[40:43], v19, s[48:51], s7 offen sc1
    s_add_u32 s7, s8, 20480
    buffer_store_dwordx4 v[40:43], v19, s[48:51], s7 offen sc1
    v_lshrrev_b32 v28, 4, v0
    v_and_b32 v29, 15, v0
    v_and_b32 v30, 7, v0
    v_lshrrev_b32 v31, 3, v0
    v_lshlrev_b32 v32, 4, v29
    s_movk_i32 s7, 0x2000
    v_mad_u32_u24 v3, v28, s7, v32
    s_movk_i32 s7, 3584
    v_mad_u32_u24 v2, v28, s7, v32
    v_lshlrev_b32 v32, 4, v30
    s_movk_i32 s7, 896
    v_mad_u32_u24 v1, v31, s7, v32
    s_mul_i32 s11, s3, 10240
    s_add_u32 s11, s11, 100352
    s_mul_i32 s10, s3, 917504
    s_lshl_b32 s7, s2, 9
    s_add_u32 s10, s10, s7
    s_add_u32 s7, s10, 0
    buffer_load_dwordx4 a[0:3], v3, s[44:47], s7 offen
    s_add_u32 s7, s10, 256
    buffer_load_dwordx4 a[4:7], v3, s[44:47], s7 offen
    s_add_u32 s7, s10, 32768
    buffer_load_dwordx4 a[8:11], v3, s[44:47], s7 offen
    s_add_u32 s7, s10, 33024
    buffer_load_dwordx4 a[12:15], v3, s[44:47], s7 offen
    s_add_u32 s7, s10, 65536
    buffer_load_dwordx4 a[16:19], v3, s[44:47], s7 offen
    s_add_u32 s7, s10, 65792
    buffer_load_dwordx4 a[20:23], v3, s[44:47], s7 offen
    s_add_u32 s7, s10, 98304
    buffer_load_dwordx4 a[24:27], v3, s[44:47], s7 offen
    s_add_u32 s7, s10, 98560
    buffer_load_dwordx4 a[28:31], v3, s[44:47], s7 offen
    s_waitcnt vmcnt(0)
    s_barrier
    v_mov_b32 v45, 0
    s_cmp_lg_u32 s3, 0
    s_cbranch_scc1 L_SVNOFLAG
    s_lshl_b32 s7, s2, 2
    v_mov_b32 v44, 1
    s_mov_b64 exec, 1
    buffer_store_dword v44, v45, s[52:55], s7 offen offset:128 sc1
    s_mov_b64 exec, -1
L_SVNOFLAG:
    s_add_u32 s7, s10, 131072
    buffer_load_dwordx4 a[32:35], v3, s[44:47], s7 offen
    s_add_u32 s7, s10, 131328
    buffer_load_dwordx4 a[36:39], v3, s[44:47], s7 offen
    s_add_u32 s7, s10, 163840
    buffer_load_dwordx4 a[40:43], v3, s[44:47], s7 offen
    s_add_u32 s7, s10, 164096
    buffer_load_dwordx4 a[44:47], v3, s[44:47], s7 offen
    s_add_u32 s7, s10, 196608
    buffer_load_dwordx4 a[48:51], v3, s[44:47], s7 offen
    s_add_u32 s7, s10, 196864
    buffer_load_dwordx4 a[52:55], v3, s[44:47], s7 offen
    s_add_u32 s7, s10, 229376
    buffer_load_dwordx4 a[56:59], v3, s[44:47], s7 offen
    s_add_u32 s7, s10, 229632
    buffer_load_dwordx4 a[60:63], v3, s[44:47], s7 offen
    s_add_u32 s7, s10, 262144
    buffer_load_dwordx4 a[64:67], v3, s[44:47], s7 offen
    s_add_u32 s7, s10, 262400
    buffer_load_dwordx4 a[68:71], v3, s[44:47], s7 offen
    s_add_u32 s7, s10, 294912
    buffer_load_dwordx4 a[72:75], v3, s[44:47], s7 offen
    s_add_u32 s7, s10, 295168
    buffer_load_dwordx4 a[76:79], v3, s[44:47], s7 offen
    s_add_u32 s7, s10, 327680
    buffer_load_dwordx4 a[80:83], v3, s[44:47], s7 offen
    s_add_u32 s7, s10, 327936
    buffer_load_dwordx4 a[84:87], v3, s[44:47], s7 offen
    s_add_u32 s7, s10, 360448
    buffer_load_dwordx4 a[88:91], v3, s[44:47], s7 offen
    s_add_u32 s7, s10, 360704
    buffer_load_dwordx4 a[92:95], v3, s[44:47], s7 offen
    s_add_u32 s7, s10, 393216
    buffer_load_dwordx4 a[96:99], v3, s[44:47], s7 offen
    s_add_u32 s7, s10, 393472
    buffer_load_dwordx4 a[100:103], v3, s[44:47], s7 offen
    s_add_u32 s7, s10, 425984
    buffer_load_dwordx4 a[104:107], v3, s[44:47], s7 offen
    s_add_u32 s7, s10, 426240
    buffer_load_dwordx4 a[108:111], v3, s[44:47], s7 offen
    s_add_u32 s7, s10, 458752
    buffer_load_dwordx4 a[112:115], v3, s[44:47], s7 offen
    s_add_u32 s7, s10, 459008
    buffer_load_dwordx4 a[116:119], v3, s[44:47], s7 offen
    s_add_u32 s7, s10, 491520
    buffer_load_dwordx4 a[120:123], v3, s[44:47], s7 offen
    s_add_u32 s7, s10, 491776
    buffer_load_dwordx4 a[124:127], v3, s[44:47], s7 offen
    s_add_u32 s7, s10, 524288
    buffer_load_dwordx4 a[128:131], v3, s[44:47], s7 offen
    s_add_u32 s7, s10, 524544
    buffer_load_dwordx4 a[132:135], v3, s[44:47], s7 offen
    s_add_u32 s7, s10, 557056
    buffer_load_dwordx4 a[136:139], v3, s[44:47], s7 offen
    s_add_u32 s7, s10, 557312
    buffer_load_dwordx4 a[140:143], v3, s[44:47], s7 offen
    s_add_u32 s7, s10, 589824
    buffer_load_dwordx4 a[144:147], v3, s[44:47], s7 offen
    s_add_u32 s7, s10, 590080
    buffer_load_dwordx4 a[148:151], v3, s[44:47], s7 offen
    s_add_u32 s7, s10, 622592
    buffer_load_dwordx4 a[152:155], v3, s[44:47], s7 offen
    s_add_u32 s7, s10, 622848
    buffer_load_dwordx4 a[156:159], v3, s[44:47], s7 offen
    s_add_u32 s7, s10, 655360
    buffer_load_dwordx4 a[160:163], v3, s[44:47], s7 offen
    s_add_u32 s7, s10, 655616
    buffer_load_dwordx4 a[164:167], v3, s[44:47], s7 offen
    s_add_u32 s7, s10, 688128
    buffer_load_dwordx4 a[168:171], v3, s[44:47], s7 offen
    s_add_u32 s7, s10, 688384
    buffer_load_dwordx4 a[172:175], v3, s[44:47], s7 offen
    s_add_u32 s7, s10, 720896
    buffer_load_dwordx4 a[176:179], v3, s[44:47], s7 offen
    s_add_u32 s7, s10, 721152
    buffer_load_dwordx4 a[180:183], v3, s[44:47], s7 offen
    s_add_u32 s7, s10, 753664
    buffer_load_dwordx4 a[184:187], v3, s[44:47], s7 offen
    s_add_u32 s7, s10, 753920
    buffer_load_dwordx4 a[188:191], v3, s[44:47], s7 offen
    s_add_u32 s7, s10, 786432
    buffer_load_dwordx4 a[192:195], v3, s[44:47], s7 offen
    s_add_u32 s7, s10, 786688
    buffer_load_dwordx4 a[196:199], v3, s[44:47], s7 offen
    s_add_u32 s7, s10, 819200
    buffer_load_dwordx4 a[200:203], v3, s[44:47], s7 offen
    s_add_u32 s7, s10, 819456
    buffer_load_dwordx4 a[204:207], v3, s[44:47], s7 offen
    s_add_u32 s7, s10, 851968
    buffer_load_dwordx4 a[208:211], v3, s[44:47], s7 offen
    s_add_u32 s7, s10, 852224
    buffer_load_dwordx4 a[212:215], v3, s[44:47], s7 offen
    s_add_u32 s7, s10, 884736
    buffer_load_dwordx4 a[216:219], v3, s[44:47], s7 offen
    s_add_u32 s7, s10, 884992
    buffer_load_dwordx4 a[220:223], v3, s[44:47], s7 offen
    s_mul_i32 s7, s3, 56
    v_add_u32 v32, s7, v0
    v_lshlrev_b32 v12, 3, v32
    v_lshlrev_b32 v32, 1, v32
    v_and_b32 v33, 0xffffffe0, v32
    v_and_b32 v34, 3, v32
    v_lshl_add_u32 v33, v34, 3, v33
    v_bfe_u32 v34, v32, 2, 3
    v_add_u32 v33, v33, v34
    v_lshlrev_b32 v23, 1, v33
    s_mov_b32 exec_lo, 0xffffffff
    s_mov_b32 exec_hi, 0xffffff
    buffer_load_ushort v36, v23, s[40:43], 0 offen offset:0
    buffer_load_ushort v37, v23, s[40:43], 0 offen offset:16
    buffer_load_ushort v38, v23, s[40:43], 0 offen offset:896
    buffer_load_ushort v39, v23, s[40:43], 0 offen offset:912
    s_mov_b64 exec, -1
    v_and_b32 v44, 7, v0
    v_and_b32 v45, 1, v0
    v_lshlrev_b32 v45, 4, v45
    v_mov_b32 v4, 0xffff
    v_lshlrev_b32 v45, v45, v4
    v_lshrrev_b32 v44, 1, v44
    v_cmp_eq_u32 vcc, 0, v44
    s_nop 1
    v_cndmask_b32 v4, 0, v45, vcc
    v_cmp_eq_u32 vcc, 1, v44
    s_nop 1
    v_cndmask_b32 v5, 0, v45, vcc
    v_cmp_eq_u32 vcc, 2, v44
    s_nop 1
    v_cndmask_b32 v6, 0, v45, vcc
    v_cmp_eq_u32 vcc, 3, v44
    s_nop 1
    v_cndmask_b32 v7, 0, v45, vcc
    v_and_b32 v44, 15, v0
    v_and_b32 v45, 1, v0
    v_lshlrev_b32 v45, 4, v45
    v_mov_b32 v8, 0xffff
    v_lshlrev_b32 v45, v45, v8
    v_lshrrev_b32 v44, 1, v44
    v_cmp_eq_u32 vcc, 0, v44
    s_nop 1
    v_cndmask_b32 v8, 0, v45, vcc
    v_cmp_eq_u32 vcc, 1, v44
    s_nop 1
    v_cndmask_b32 v9, 0, v45, vcc
    v_cmp_eq_u32 vcc, 2, v44
    s_nop 1
    v_cndmask_b32 v10, 0, v45, vcc
    v_cmp_eq_u32 vcc, 3, v44
    s_nop 1
    v_cndmask_b32 v11, 0, v45, vcc
    v_mov_b32 v22, 0
    v_lshlrev_b32 v21, 2, v0
    v_add_u32 v21, 141312, v21
    v_lshrrev_b32 v32, 2, v30
    v_lshlrev_b32 v32, 5, v32
    v_lshl_add_u32 v32, v31, 2, v32
    v_and_b32 v33, 3, v0
    v_add_u32 v32, v32, v33
    s_lshl_b32 s7, s3, 6
    v_add_u32 v32, s7, v32
    v_lshlrev_b32 v13, 2, v32
    v_min_u32 v32, 14, v29
    v_mul_u32_u24 v32, 1152, v32
    v_add_u32 v14, 1024, v32
    v_lshrrev_b32 v32, 1, v28
    s_lshl_b32 s7, s3, 1
    v_add_u32 v32, s7, v32
    v_mul_u32_u24 v32, 1792, v32
    v_and_b32 v33, 1, v28
    v_lshlrev_b32 v33, 7, v33
    v_lshl_add_u32 v33, v30, 4, v33
    v_add_u32 v32, v32, v33
    v_add_u32 v15, 144896, v32
    s_lshl_b32 s7, s3, 9
    v_add_u32 v20, s7, v33
    s_mul_i32 s7, s3, 112
    v_lshl_add_u32 v32, v29, 2, v28
    v_add_u32 v32, s7, v32
    v_and_b32 v33, 0xffffffe0, v32
    v_and_b32 v34, 7, v32
    v_lshl_add_u32 v33, v34, 2, v33
    v_bfe_u32 v34, v32, 3, 2
    v_add_u32 v33, v33, v34
    v_lshlrev_b32 v33, 2, v33
    v_add_u32 v16, 141312, v33
    v_lshl_add_u32 v32, v28, 5, v29
    v_lshlrev_b32 v32, 4, v32
    s_lshl_b32 s7, s3, 2
    s_add_u32 s7, s7, 159232
    v_add_u32 v17, s7, v32
    v_lshl_add_u32 v32, v30, 3, v31
    v_lshlrev_b32 v32, 4, v32
    v_add_u32 v18, 159232, v32
    s_waitcnt vmcnt(0)
    v_lshlrev_b32 v36, 16, v36
    v_lshlrev_b32 v37, 16, v37
    v_lshlrev_b32 v38, 16, v38
    v_lshlrev_b32 v39, 16, v39
    v_add_u32 v12, 141312, v12
    s_mov_b32 exec_lo, 0xffffffff
    s_mov_b32 exec_hi, 0xffffff
    ds_write_b64 v12, v[36:37]
    ds_write_b64 v12, v[38:39] offset:1792
    s_mov_b64 exec, -1
    v_subrev_u32 v12, 141312, v12
    s_waitcnt lgkmcnt(0)
    s_barrier
    s_mov_b32 s4, 0
L_SVQ0:
    s_mul_i32 s5, s4, 1792
    v_add_u32 v38, s5, v21
    v_add_u32 v39, s5, v16
    s_add_u32 s7, s5, 141312
    v_mov_b32 v37, s7
    ds_read_b32 v37, v37
    ds_read2st64_b32 v[28:29], v38 offset0:0 offset1:1
    ds_read2st64_b32 v[30:31], v38 offset0:2 offset1:3
    ds_read2st64_b32 v[32:33], v38 offset0:4 offset1:5
    ds_read_b32 v34, v38 offset:1536
    ds_read_b32 v40, v39
    ds_read_b32 v41, v39 offset:256
    s_waitcnt lgkmcnt(2)
    v_sub_f32 v28, v28, v37
    v_sub_f32 v29, v29, v37
    v_sub_f32 v30, v30, v37
    v_sub_f32 v31, v31, v37
    v_sub_f32 v32, v32, v37
    v_sub_f32 v33, v33, v37
    v_sub_f32 v34, v34, v37
    v_add_f32 v36, v28, v29
    v_mul_f32 v35, v28, v28
    v_fmac_f32 v35, v29, v29
    v_fmac_f32 v35, v30, v30
    v_add_f32 v36, v36, v30
    v_fmac_f32 v35, v31, v31
    v_add_f32 v36, v36, v31
    v_fmac_f32 v35, v32, v32
    v_add_f32 v36, v36, v32
    v_fmac_f32 v35, v33, v33
    v_add_f32 v36, v36, v33
    v_fmac_f32 v35, v34, v34
    v_add_f32 v36, v36, v34
    s_nop 0
    s_nop 0
    v_add_f32_dpp v36, v36, v36 quad_perm:[1,0,3,2] row_mask:0xf bank_mask:0xf
    v_add_f32_dpp v35, v35, v35 quad_perm:[1,0,3,2] row_mask:0xf bank_mask:0xf
    s_nop 0
    v_add_f32_dpp v36, v36, v36 quad_perm:[2,3,0,1] row_mask:0xf bank_mask:0xf
    v_add_f32_dpp v35, v35, v35 quad_perm:[2,3,0,1] row_mask:0xf bank_mask:0xf
    s_nop 0
    v_add_f32_dpp v36, v36, v36 row_half_mirror row_mask:0xf bank_mask:0xf
    v_add_f32_dpp v35, v35, v35 row_half_mirror row_mask:0xf bank_mask:0xf
    s_nop 0
    v_add_f32_dpp v36, v36, v36 row_mirror row_mask:0xf bank_mask:0xf
    v_add_f32_dpp v35, v35, v35 row_mirror row_mask:0xf bank_mask:0xf
    v_mov_b32 v38, v36
    v_mov_b32 v39, v35
    s_nop 0
    v_permlane16_swap_b32 v36, v38
    v_permlane16_swap_b32 v35, v39
    v_add_f32 v36, v36, v38
    v_add_f32 v35, v35, v39
    v_mov_b32 v38, v36
    v_mov_b32 v39, v35
    s_nop 0
    v_permlane32_swap_b32 v36, v38
    v_permlane32_swap_b32 v35, v39
    v_add_f32 v36, v36, v38
    v_add_f32 v35, v35, v39
    v_mul_f32 v36, 0x3b124925, v36
    v_mul_f32 v35, 0x3b124925, v35
    v_fma_f32 v35, -v36, v36, v35
    v_add_f32 v36, v36, v37
    v_max_f32 v35, 0, v35
    v_cvt_pk_bf16_f32 v36, v36, v36
    v_and_b32 v36, 0xffff0000, v36
    v_cvt_pk_bf16_f32 v35, v35, v35
    v_and_b32 v35, 0xffff0000, v35
    s_waitcnt lgkmcnt(0)
    v_add_f32 v35, 0x3727c5ac, v35
    v_sub_f32 v40, v40, v36
    v_sub_f32 v41, v41, v36
    v_cvt_pk_bf16_f32 v35, v35, v35
    v_and_b32 v35, 0xffff0000, v35
    v_sqrt_f32 v35, v35
    v_cvt_pk_bf16_f32 v40, v40, v40
    v_and_b32 v40, 0xffff0000, v40
    v_cvt_pk_bf16_f32 v41, v41, v41
    v_and_b32 v41, 0xffff0000, v41
    v_cvt_pk_bf16_f32 v35, v35, v35
    v_and_b32 v35, 0xffff0000, v35
    v_rcp_f32 v35, v35
    s_nop 0
    v_mul_f32 v40, v40, v35
    v_mul_f32 v41, v41, v35
    v_cvt_pk_bf16_f32 v40, v40, v40
    v_cvt_pk_bf16_f32 v41, v41, v41
    s_nop 0
    v_and_b32_dpp v24, v40, v8 row_newbcast:0 row_mask:0xf bank_mask:0xf
    v_and_b32_dpp v25, v40, v9 row_newbcast:0 row_mask:0xf bank_mask:0xf
    v_and_b32_dpp v26, v40, v10 row_newbcast:0 row_mask:0xf bank_mask:0xf
    v_and_b32_dpp v27, v40, v11 row_newbcast:0 row_mask:0xf bank_mask:0xf
    s_nop 0
    s_nop 0
    v_mfma_f32_16x16x32_bf16 v[44:47], a[0:3], v[24:27], 0
    v_and_b32_dpp v52, v40, v8 row_newbcast:1 row_mask:0xf bank_mask:0xf
    v_and_b32_dpp v53, v40, v9 row_newbcast:1 row_mask:0xf bank_mask:0xf
    v_and_b32_dpp v54, v40, v10 row_newbcast:1 row_mask:0xf bank_mask:0xf
    v_and_b32_dpp v55, v40, v11 row_newbcast:1 row_mask:0xf bank_mask:0xf
    v_mfma_f32_16x16x32_bf16 v[48:51], a[4:7], v[24:27], 0
    s_nop 0
    v_mfma_f32_16x16x32_bf16 v[44:47], a[8:11], v[52:55], v[44:47]
    v_and_b32_dpp v24, v40, v8 row_newbcast:2 row_mask:0xf bank_mask:0xf
    v_and_b32_dpp v25, v40, v9 row_newbcast:2 row_mask:0xf bank_mask:0xf
    v_and_b32_dpp v26, v40, v10 row_newbcast:2 row_mask:0xf bank_mask:0xf
    v_and_b32_dpp v27, v40, v11 row_newbcast:2 row_mask:0xf bank_mask:0xf
    v_mfma_f32_16x16x32_bf16 v[48:51], a[12:15], v[52:55], v[48:51]
    s_nop 0
    v_mfma_f32_16x16x32_bf16 v[44:47], a[16:19], v[24:27], v[44:47]
    v_and_b32_dpp v52, v40, v8 row_newbcast:3 row_mask:0xf bank_mask:0xf
    v_and_b32_dpp v53, v40, v9 row_newbcast:3 row_mask:0xf bank_mask:0xf
    v_and_b32_dpp v54, v40, v10 row_newbcast:3 row_mask:0xf bank_mask:0xf
    v_and_b32_dpp v55, v40, v11 row_newbcast:3 row_mask:0xf bank_mask:0xf
    v_mfma_f32_16x16x32_bf16 v[48:51], a[20:23], v[24:27], v[48:51]
    s_nop 0
    v_mfma_f32_16x16x32_bf16 v[44:47], a[24:27], v[52:55], v[44:47]
    v_and_b32_dpp v24, v40, v8 row_newbcast:4 row_mask:0xf bank_mask:0xf
    v_and_b32_dpp v25, v40, v9 row_newbcast:4 row_mask:0xf bank_mask:0xf
    v_and_b32_dpp v26, v40, v10 row_newbcast:4 row_mask:0xf bank_mask:0xf
    v_and_b32_dpp v27, v40, v11 row_newbcast:4 row_mask:0xf bank_mask:0xf
    v_mfma_f32_16x16x32_bf16 v[48:51], a[28:31], v[52:55], v[48:51]
    s_nop 0
    v_mfma_f32_16x16x32_bf16 v[44:47], a[32:35], v[24:27], v[44:47]
    v_and_b32_dpp v52, v40, v8 row_newbcast:5 row_mask:0xf bank_mask:0xf
    v_and_b32_dpp v53, v40, v9 row_newbcast:5 row_mask:0xf bank_mask:0xf
    v_and_b32_dpp v54, v40, v10 row_newbcast:5 row_mask:0xf bank_mask:0xf
    v_and_b32_dpp v55, v40, v11 row_newbcast:5 row_mask:0xf bank_mask:0xf
    v_mfma_f32_16x16x32_bf16 v[48:51], a[36:39], v[24:27], v[48:51]
    s_nop 0
    v_mfma_f32_16x16x32_bf16 v[44:47], a[40:43], v[52:55], v[44:47]
    v_and_b32_dpp v24, v40, v8 row_newbcast:6 row_mask:0xf bank_mask:0xf
    v_and_b32_dpp v25, v40, v9 row_newbcast:6 row_mask:0xf bank_mask:0xf
    v_and_b32_dpp v26, v40, v10 row_newbcast:6 row_mask:0xf bank_mask:0xf
    v_and_b32_dpp v27, v40, v11 row_newbcast:6 row_mask:0xf bank_mask:0xf
    v_mfma_f32_16x16x32_bf16 v[48:51], a[44:47], v[52:55], v[48:51]
    s_nop 0
    v_mfma_f32_16x16x32_bf16 v[44:47], a[48:51], v[24:27], v[44:47]
    v_and_b32_dpp v52, v40, v8 row_newbcast:7 row_mask:0xf bank_mask:0xf
    v_and_b32_dpp v53, v40, v9 row_newbcast:7 row_mask:0xf bank_mask:0xf
    v_and_b32_dpp v54, v40, v10 row_newbcast:7 row_mask:0xf bank_mask:0xf
    v_and_b32_dpp v55, v40, v11 row_newbcast:7 row_mask:0xf bank_mask:0xf
    v_mfma_f32_16x16x32_bf16 v[48:51], a[52:55], v[24:27], v[48:51]
    s_nop 0
    v_mfma_f32_16x16x32_bf16 v[44:47], a[56:59], v[52:55], v[44:47]
    v_and_b32_dpp v24, v40, v8 row_newbcast:8 row_mask:0xf bank_mask:0xf
    v_and_b32_dpp v25, v40, v9 row_newbcast:8 row_mask:0xf bank_mask:0xf
    v_and_b32_dpp v26, v40, v10 row_newbcast:8 row_mask:0xf bank_mask:0xf
    v_and_b32_dpp v27, v40, v11 row_newbcast:8 row_mask:0xf bank_mask:0xf
    v_mfma_f32_16x16x32_bf16 v[48:51], a[60:63], v[52:55], v[48:51]
    s_nop 0
    v_mfma_f32_16x16x32_bf16 v[44:47], a[64:67], v[24:27], v[44:47]
    v_and_b32_dpp v52, v40, v8 row_newbcast:9 row_mask:0xf bank_mask:0xf
    v_and_b32_dpp v53, v40, v9 row_newbcast:9 row_mask:0xf bank_mask:0xf
    v_and_b32_dpp v54, v40, v10 row_newbcast:9 row_mask:0xf bank_mask:0xf
    v_and_b32_dpp v55, v40, v11 row_newbcast:9 row_mask:0xf bank_mask:0xf
    v_mfma_f32_16x16x32_bf16 v[48:51], a[68:71], v[24:27], v[48:51]
    s_nop 0
    v_mfma_f32_16x16x32_bf16 v[44:47], a[72:75], v[52:55], v[44:47]
    v_and_b32_dpp v24, v40, v8 row_newbcast:10 row_mask:0xf bank_mask:0xf
    v_and_b32_dpp v25, v40, v9 row_newbcast:10 row_mask:0xf bank_mask:0xf
    v_and_b32_dpp v26, v40, v10 row_newbcast:10 row_mask:0xf bank_mask:0xf
    v_and_b32_dpp v27, v40, v11 row_newbcast:10 row_mask:0xf bank_mask:0xf
    v_mfma_f32_16x16x32_bf16 v[48:51], a[76:79], v[52:55], v[48:51]
    s_nop 0
    v_mfma_f32_16x16x32_bf16 v[44:47], a[80:83], v[24:27], v[44:47]
    v_and_b32_dpp v52, v40, v8 row_newbcast:11 row_mask:0xf bank_mask:0xf
    v_and_b32_dpp v53, v40, v9 row_newbcast:11 row_mask:0xf bank_mask:0xf
    v_and_b32_dpp v54, v40, v10 row_newbcast:11 row_mask:0xf bank_mask:0xf
    v_and_b32_dpp v55, v40, v11 row_newbcast:11 row_mask:0xf bank_mask:0xf
    v_mfma_f32_16x16x32_bf16 v[48:51], a[84:87], v[24:27], v[48:51]
    s_nop 0
    v_mfma_f32_16x16x32_bf16 v[44:47], a[88:91], v[52:55], v[44:47]
    v_and_b32_dpp v24, v40, v8 row_newbcast:12 row_mask:0xf bank_mask:0xf
    v_and_b32_dpp v25, v40, v9 row_newbcast:12 row_mask:0xf bank_mask:0xf
    v_and_b32_dpp v26, v40, v10 row_newbcast:12 row_mask:0xf bank_mask:0xf
    v_and_b32_dpp v27, v40, v11 row_newbcast:12 row_mask:0xf bank_mask:0xf
    v_mfma_f32_16x16x32_bf16 v[48:51], a[92:95], v[52:55], v[48:51]
    s_nop 0
    v_mfma_f32_16x16x32_bf16 v[44:47], a[96:99], v[24:27], v[44:47]
    v_and_b32_dpp v52, v40, v8 row_newbcast:13 row_mask:0xf bank_mask:0xf
    v_and_b32_dpp v53, v40, v9 row_newbcast:13 row_mask:0xf bank_mask:0xf
    v_and_b32_dpp v54, v40, v10 row_newbcast:13 row_mask:0xf bank_mask:0xf
    v_and_b32_dpp v55, v40, v11 row_newbcast:13 row_mask:0xf bank_mask:0xf
    v_mfma_f32_16x16x32_bf16 v[48:51], a[100:103], v[24:27], v[48:51]
    s_nop 0
    v_mfma_f32_16x16x32_bf16 v[44:47], a[104:107], v[52:55], v[44:47]
    v_and_b32_dpp v24, v40, v8 row_newbcast:14 row_mask:0xf bank_mask:0xf
    v_and_b32_dpp v25, v40, v9 row_newbcast:14 row_mask:0xf bank_mask:0xf
    v_and_b32_dpp v26, v40, v10 row_newbcast:14 row_mask:0xf bank_mask:0xf
    v_and_b32_dpp v27, v40, v11 row_newbcast:14 row_mask:0xf bank_mask:0xf
    v_mfma_f32_16x16x32_bf16 v[48:51], a[108:111], v[52:55], v[48:51]
    s_nop 0
    v_mfma_f32_16x16x32_bf16 v[44:47], a[112:115], v[24:27], v[44:47]
    v_and_b32_dpp v52, v40, v8 row_newbcast:15 row_mask:0xf bank_mask:0xf
    v_and_b32_dpp v53, v40, v9 row_newbcast:15 row_mask:0xf bank_mask:0xf
    v_and_b32_dpp v54, v40, v10 row_newbcast:15 row_mask:0xf bank_mask:0xf
    v_and_b32_dpp v55, v40, v11 row_newbcast:15 row_mask:0xf bank_mask:0xf
    v_mfma_f32_16x16x32_bf16 v[48:51], a[116:119], v[24:27], v[48:51]
    s_nop 0
    v_mfma_f32_16x16x32_bf16 v[44:47], a[120:123], v[52:55], v[44:47]
    v_and_b32_dpp v24, v41, v8 row_newbcast:0 row_mask:0xf bank_mask:0xf
    v_and_b32_dpp v25, v41, v9 row_newbcast:0 row_mask:0xf bank_mask:0xf
    v_and_b32_dpp v26, v41, v10 row_newbcast:0 row_mask:0xf bank_mask:0xf
    v_and_b32_dpp v27, v41, v11 row_newbcast:0 row_mask:0xf bank_mask:0xf
    v_mfma_f32_16x16x32_bf16 v[48:51], a[124:127], v[52:55], v[48:51]
    s_nop 0
    v_mfma_f32_16x16x32_bf16 v[44:47], a[128:131], v[24:27], v[44:47]
    v_and_b32_dpp v52, v41, v8 row_newbcast:1 row_mask:0xf bank_mask:0xf
    v_and_b32_dpp v53, v41, v9 row_newbcast:1 row_mask:0xf bank_mask:0xf
    v_and_b32_dpp v54, v41, v10 row_newbcast:1 row_mask:0xf bank_mask:0xf
    v_and_b32_dpp v55, v41, v11 row_newbcast:1 row_mask:0xf bank_mask:0xf
    v_mfma_f32_16x16x32_bf16 v[48:51], a[132:135], v[24:27], v[48:51]
    s_nop 0
    v_mfma_f32_16x16x32_bf16 v[44:47], a[136:139], v[52:55], v[44:47]
    v_and_b32_dpp v24, v41, v8 row_newbcast:2 row_mask:0xf bank_mask:0xf
    v_and_b32_dpp v25, v41, v9 row_newbcast:2 row_mask:0xf bank_mask:0xf
    v_and_b32_dpp v26, v41, v10 row_newbcast:2 row_mask:0xf bank_mask:0xf
    v_and_b32_dpp v27, v41, v11 row_newbcast:2 row_mask:0xf bank_mask:0xf
    v_mfma_f32_16x16x32_bf16 v[48:51], a[140:143], v[52:55], v[48:51]
    s_nop 0
    v_mfma_f32_16x16x32_bf16 v[44:47], a[144:147], v[24:27], v[44:47]
    v_and_b32_dpp v52, v41, v8 row_newbcast:3 row_mask:0xf bank_mask:0xf
    v_and_b32_dpp v53, v41, v9 row_newbcast:3 row_mask:0xf bank_mask:0xf
    v_and_b32_dpp v54, v41, v10 row_newbcast:3 row_mask:0xf bank_mask:0xf
    v_and_b32_dpp v55, v41, v11 row_newbcast:3 row_mask:0xf bank_mask:0xf
    v_mfma_f32_16x16x32_bf16 v[48:51], a[148:151], v[24:27], v[48:51]
    s_nop 0
    v_mfma_f32_16x16x32_bf16 v[44:47], a[152:155], v[52:55], v[44:47]
    v_and_b32_dpp v24, v41, v8 row_newbcast:4 row_mask:0xf bank_mask:0xf
    v_and_b32_dpp v25, v41, v9 row_newbcast:4 row_mask:0xf bank_mask:0xf
    v_and_b32_dpp v26, v41, v10 row_newbcast:4 row_mask:0xf bank_mask:0xf
    v_and_b32_dpp v27, v41, v11 row_newbcast:4 row_mask:0xf bank_mask:0xf
    v_mfma_f32_16x16x32_bf16 v[48:51], a[156:159], v[52:55], v[48:51]
    s_nop 0
    v_mfma_f32_16x16x32_bf16 v[44:47], a[160:163], v[24:27], v[44:47]
    v_and_b32_dpp v52, v41, v8 row_newbcast:5 row_mask:0xf bank_mask:0xf
    v_and_b32_dpp v53, v41, v9 row_newbcast:5 row_mask:0xf bank_mask:0xf
    v_and_b32_dpp v54, v41, v10 row_newbcast:5 row_mask:0xf bank_mask:0xf
    v_and_b32_dpp v55, v41, v11 row_newbcast:5 row_mask:0xf bank_mask:0xf
    v_mfma_f32_16x16x32_bf16 v[48:51], a[164:167], v[24:27], v[48:51]
    s_nop 0
    v_mfma_f32_16x16x32_bf16 v[44:47], a[168:171], v[52:55], v[44:47]
    v_and_b32_dpp v24, v41, v8 row_newbcast:6 row_mask:0xf bank_mask:0xf
    v_and_b32_dpp v25, v41, v9 row_newbcast:6 row_mask:0xf bank_mask:0xf
    v_and_b32_dpp v26, v41, v10 row_newbcast:6 row_mask:0xf bank_mask:0xf
    v_and_b32_dpp v27, v41, v11 row_newbcast:6 row_mask:0xf bank_mask:0xf
    v_mfma_f32_16x16x32_bf16 v[48:51], a[172:175], v[52:55], v[48:51]
    s_nop 0
    v_mfma_f32_16x16x32_bf16 v[44:47], a[176:179], v[24:27], v[44:47]
    v_and_b32_dpp v52, v41, v8 row_newbcast:7 row_mask:0xf bank_mask:0xf
    v_and_b32_dpp v53, v41, v9 row_newbcast:7 row_mask:0xf bank_mask:0xf
    v_and_b32_dpp v54, v41, v10 row_newbcast:7 row_mask:0xf bank_mask:0xf
    v_and_b32_dpp v55, v41, v11 row_newbcast:7 row_mask:0xf bank_mask:0xf
    v_mfma_f32_16x16x32_bf16 v[48:51], a[180:183], v[24:27], v[48:51]
    s_nop 0
    v_mfma_f32_16x16x32_bf16 v[44:47], a[184:187], v[52:55], v[44:47]
    v_and_b32_dpp v24, v41, v8 row_newbcast:8 row_mask:0xf bank_mask:0xf
    v_and_b32_dpp v25, v41, v9 row_newbcast:8 row_mask:0xf bank_mask:0xf
    v_and_b32_dpp v26, v41, v10 row_newbcast:8 row_mask:0xf bank_mask:0xf
    v_and_b32_dpp v27, v41, v11 row_newbcast:8 row_mask:0xf bank_mask:0xf
    v_mfma_f32_16x16x32_bf16 v[48:51], a[188:191], v[52:55], v[48:51]
    s_nop 0
    v_mfma_f32_16x16x32_bf16 v[44:47], a[192:195], v[24:27], v[44:47]
    v_and_b32_dpp v52, v41, v8 row_newbcast:9 row_mask:0xf bank_mask:0xf
    v_and_b32_dpp v53, v41, v9 row_newbcast:9 row_mask:0xf bank_mask:0xf
    v_and_b32_dpp v54, v41, v10 row_newbcast:9 row_mask:0xf bank_mask:0xf
    v_and_b32_dpp v55, v41, v11 row_newbcast:9 row_mask:0xf bank_mask:0xf
    v_mfma_f32_16x16x32_bf16 v[48:51], a[196:199], v[24:27], v[48:51]
    s_nop 0
    v_mfma_f32_16x16x32_bf16 v[44:47], a[200:203], v[52:55], v[44:47]
    v_and_b32_dpp v24, v41, v8 row_newbcast:10 row_mask:0xf bank_mask:0xf
    v_and_b32_dpp v25, v41, v9 row_newbcast:10 row_mask:0xf bank_mask:0xf
    v_and_b32_dpp v26, v41, v10 row_newbcast:10 row_mask:0xf bank_mask:0xf
    v_and_b32_dpp v27, v41, v11 row_newbcast:10 row_mask:0xf bank_mask:0xf
    v_mfma_f32_16x16x32_bf16 v[48:51], a[204:207], v[52:55], v[48:51]
    s_nop 0
    v_mfma_f32_16x16x32_bf16 v[44:47], a[208:211], v[24:27], v[44:47]
    v_and_b32_dpp v52, v41, v8 row_newbcast:11 row_mask:0xf bank_mask:0xf
    v_and_b32_dpp v53, v41, v9 row_newbcast:11 row_mask:0xf bank_mask:0xf
    v_and_b32_dpp v54, v41, v10 row_newbcast:11 row_mask:0xf bank_mask:0xf
    v_and_b32_dpp v55, v41, v11 row_newbcast:11 row_mask:0xf bank_mask:0xf
    v_mfma_f32_16x16x32_bf16 v[48:51], a[212:215], v[24:27], v[48:51]
    s_nop 0
    v_mfma_f32_16x16x32_bf16 v[44:47], a[216:219], v[52:55], v[44:47]
    v_mfma_f32_16x16x32_bf16 v[48:51], a[220:223], v[52:55], v[48:51]
    s_nop 7
    s_mov_b32 exec_lo, 0xff00ff
    s_mov_b32 exec_hi, 0xff00ff
    ds_write_b32 v17, v44 offset:0
    ds_write_b32 v17, v45 offset:128
    ds_write_b32 v17, v46 offset:256
    ds_write_b32 v17, v47 offset:384
    ds_write_b32 v17, v48 offset:2048
    ds_write_b32 v17, v49 offset:2176
    ds_write_b32 v17, v50 offset:2304
    ds_write_b32 v17, v51 offset:2432
    s_mov_b64 exec, -1
    s_waitcnt lgkmcnt(0)
    s_barrier
    s_cmp_ge_u32 s3, 2
    s_cbranch_scc1 L_SVQ0DONE
    s_lshl_b32 s7, s3, 11
    s_add_u32 s7, s7, 159232
    v_lshl_add_u32 v36, v0, 5, s7
    ds_read_b128 v[28:31], v36
    ds_read_b128 v[32:35], v36 offset:16
    s_lshl_b32 s8, s4, 9
    s_add_u32 s8, s8, s6
    s_lshl_b32 s7, s3, 8
    s_add_u32 s8, s8, s7
    v_lshlrev_b32 v37, 2, v0
    s_waitcnt lgkmcnt(0)
    v_add_f32 v28, v28, v29
    v_add_f32 v30, v30, v31
    v_add_f32 v28, v28, v30
    v_add_f32 v32, v32, v33
    v_add_f32 v34, v34, v35
    v_add_f32 v32, v32, v34
    v_cvt_pk_bf16_f32 v28, v28, v32
    v_min_u32 v28, -2, v28
    buffer_store_dword v28, v37, s[48:51], s8 offen offset:256 sc1
L_SVQ0DONE:
    s_waitcnt lgkmcnt(0)
    s_barrier
    s_add_u32 s4, s4, 1
    s_cmp_lt_u32 s4, 2
    s_cbranch_scc1 L_SVQ0
    s_add_u32 m0, s11, 0
    s_add_u32 s7, s10, 753664
    buffer_load_dwordx4 v3, s[44:47], s7 offen lds
    s_add_u32 m0, s11, 1024
    s_add_u32 s7, s10, 753920
    buffer_load_dwordx4 v3, s[44:47], s7 offen lds
    s_add_u32 m0, s11, 2048
    s_add_u32 s7, s10, 786432
    buffer_load_dwordx4 v3, s[44:47], s7 offen lds
    s_add_u32 m0, s11, 3072
    s_add_u32 s7, s10, 786688
    buffer_load_dwordx4 v3, s[44:47], s7 offen lds
    s_add_u32 m0, s11, 4096
    s_add_u32 s7, s10, 819200
    buffer_load_dwordx4 v3, s[44:47], s7 offen lds
    s_add_u32 m0, s11, 5120
    s_add_u32 s7, s10, 819456
    buffer_load_dwordx4 v3, s[44:47], s7 offen lds
    s_add_u32 m0, s11, 6144
    s_add_u32 s7, s10, 851968
    buffer_load_dwordx4 v3, s[44:47], s7 offen lds
    s_add_u32 m0, s11, 7168
    s_add_u32 s7, s10, 852224
    buffer_load_dwordx4 v3, s[44:47], s7 offen lds
    s_add_u32 m0, s11, 8192
    s_add_u32 s7, s10, 884736
    buffer_load_dwordx4 v3, s[44:47], s7 offen lds
    s_add_u32 m0, s11, 9216
    s_add_u32 s7, s10, 884992
    buffer_load_dwordx4 v3, s[44:47], s7 offen lds
    s_lshl_b32 s8, s2, 8
    s_lshl_b32 s7, s3, 6
    s_add_u32 s8, s8, s7
    s_mul_i32 s8, s8, 896
    s_add_u32 s7, s8, 0
    buffer_load_dwordx4 a[0:3], v1, s[56:59], s7 offen offset:0 nt
    buffer_load_dwordx4 a[4:7], v1, s[56:59], s7 offen offset:128 nt
    buffer_load_dwordx4 a[8:11], v1, s[56:59], s7 offen offset:256 nt
    buffer_load_dwordx4 a[12:15], v1, s[56:59], s7 offen offset:384 nt
    buffer_load_dwordx4 a[16:19], v1, s[56:59], s7 offen offset:512 nt
    buffer_load_dwordx4 a[20:23], v1, s[56:59], s7 offen offset:640 nt
    buffer_load_dwordx4 a[24:27], v1, s[56:59], s7 offen offset:768 nt
    s_add_u32 s7, s8, 7168
    buffer_load_dwordx4 a[28:31], v1, s[56:59], s7 offen offset:0 nt
    buffer_load_dwordx4 a[32:35], v1, s[56:59], s7 offen offset:128 nt
    buffer_load_dwordx4 a[36:39], v1, s[56:59], s7 offen offset:256 nt
    buffer_load_dwordx4 a[40:43], v1, s[56:59], s7 offen offset:384 nt
    buffer_load_dwordx4 a[44:47], v1, s[56:59], s7 offen offset:512 nt
    buffer_load_dwordx4 a[48:51], v1, s[56:59], s7 offen offset:640 nt
    buffer_load_dwordx4 a[52:55], v1, s[56:59], s7 offen offset:768 nt
    s_add_u32 s7, s8, 14336
    buffer_load_dwordx4 a[56:59], v1, s[56:59], s7 offen offset:0 nt
    buffer_load_dwordx4 a[60:63], v1, s[56:59], s7 offen offset:128 nt
    buffer_load_dwordx4 a[64:67], v1, s[56:59], s7 offen offset:256 nt
    buffer_load_dwordx4 a[68:71], v1, s[56:59], s7 offen offset:384 nt
    buffer_load_dwordx4 a[72:75], v1, s[56:59], s7 offen offset:512 nt
    buffer_load_dwordx4 a[76:79], v1, s[56:59], s7 offen offset:640 nt
    buffer_load_dwordx4 a[80:83], v1, s[56:59], s7 offen offset:768 nt
    s_add_u32 s7, s8, 21504
    buffer_load_dwordx4 a[84:87], v1, s[56:59], s7 offen offset:0 nt
    buffer_load_dwordx4 a[88:91], v1, s[56:59], s7 offen offset:128 nt
    buffer_load_dwordx4 a[92:95], v1, s[56:59], s7 offen offset:256 nt
    buffer_load_dwordx4 a[96:99], v1, s[56:59], s7 offen offset:384 nt
    buffer_load_dwordx4 a[100:103], v1, s[56:59], s7 offen offset:512 nt
    buffer_load_dwordx4 a[104:107], v1, s[56:59], s7 offen offset:640 nt
    buffer_load_dwordx4 a[108:111], v1, s[56:59], s7 offen offset:768 nt
    s_add_u32 s7, s8, 28672
    buffer_load_dwordx4 a[112:115], v1, s[56:59], s7 offen offset:0 nt
    buffer_load_dwordx4 a[116:119], v1, s[56:59], s7 offen offset:128 nt
    buffer_load_dwordx4 a[120:123], v1, s[56:59], s7 offen offset:256 nt
    buffer_load_dwordx4 a[124:127], v1, s[56:59], s7 offen offset:384 nt
    buffer_load_dwordx4 a[128:131], v1, s[56:59], s7 offen offset:512 nt
    buffer_load_dwordx4 a[132:135], v1, s[56:59], s7 offen offset:640 nt
    buffer_load_dwordx4 a[136:139], v1, s[56:59], s7 offen offset:768 nt
    s_add_u32 s7, s8, 35840
    buffer_load_dwordx4 a[140:143], v1, s[56:59], s7 offen offset:0 nt
    buffer_load_dwordx4 a[144:147], v1, s[56:59], s7 offen offset:128 nt
    buffer_load_dwordx4 a[148:151], v1, s[56:59], s7 offen offset:256 nt
    buffer_load_dwordx4 a[152:155], v1, s[56:59], s7 offen offset:384 nt
    buffer_load_dwordx4 a[156:159], v1, s[56:59], s7 offen offset:512 nt
    buffer_load_dwordx4 a[160:163], v1, s[56:59], s7 offen offset:640 nt
    buffer_load_dwordx4 a[164:167], v1, s[56:59], s7 offen offset:768 nt
    s_add_u32 s7, s8, 43008
    buffer_load_dwordx4 a[168:171], v1, s[56:59], s7 offen offset:0 nt
    buffer_load_dwordx4 a[172:175], v1, s[56:59], s7 offen offset:128 nt
    buffer_load_dwordx4 a[176:179], v1, s[56:59], s7 offen offset:256 nt
    buffer_load_dwordx4 a[180:183], v1, s[56:59], s7 offen offset:384 nt
    buffer_load_dwordx4 a[184:187], v1, s[56:59], s7 offen offset:512 nt
    buffer_load_dwordx4 a[188:191], v1, s[56:59], s7 offen offset:640 nt
    buffer_load_dwordx4 a[192:195], v1, s[56:59], s7 offen offset:768 nt
    s_add_u32 s7, s8, 50176
    buffer_load_dwordx4 a[196:199], v1, s[56:59], s7 offen offset:0 nt
    buffer_load_dwordx4 a[200:203], v1, s[56:59], s7 offen offset:128 nt
    buffer_load_dwordx4 a[204:207], v1, s[56:59], s7 offen offset:256 nt
    buffer_load_dwordx4 a[208:211], v1, s[56:59], s7 offen offset:384 nt
    buffer_load_dwordx4 a[212:215], v1, s[56:59], s7 offen offset:512 nt
    buffer_load_dwordx4 a[216:219], v1, s[56:59], s7 offen offset:640 nt
    buffer_load_dwordx4 a[220:223], v1, s[56:59], s7 offen offset:768 nt
    s_mul_i32 s8, s3, 401408
    s_mul_i32 s7, s2, 224
    s_add_u32 s8, s8, s7
    s_add_u32 s7, s8, 0
    buffer_load_dwordx4 a[224:227], v2, s[60:63], s7 offen
    buffer_load_dwordx4 a[228:231], v2, s[64:67], s7 offen
    s_add_u32 s7, s8, 14336
    buffer_load_dwordx4 a[232:235], v2, s[60:63], s7 offen
    buffer_load_dwordx4 a[236:239], v2, s[64:67], s7 offen
    s_add_u32 s7, s8, 28672
    buffer_load_dwordx4 a[240:243], v2, s[60:63], s7 offen
    buffer_load_dwordx4 a[244:247], v2, s[64:67], s7 offen
    s_add_u32 s7, s8, 43008
    buffer_load_dwordx4 a[248:251], v2, s[60:63], s7 offen
    buffer_load_dwordx4 a[252:255], v2, s[64:67], s7 offen
    s_add_u32 s7, s8, 57344
    buffer_load_dwordx4 v[64:67], v2, s[60:63], s7 offen
    buffer_load_dwordx4 v[68:71], v2, s[64:67], s7 offen
    s_add_u32 s7, s8, 71680
    buffer_load_dwordx4 v[72:75], v2, s[60:63], s7 offen
    buffer_load_dwordx4 v[76:79], v2, s[64:67], s7 offen
    s_add_u32 s7, s8, 86016
    buffer_load_dwordx4 v[80:83], v2, s[60:63], s7 offen
    buffer_load_dwordx4 v[84:87], v2, s[64:67], s7 offen
    s_add_u32 s7, s8, 100352
    buffer_load_dwordx4 v[88:91], v2, s[60:63], s7 offen
    buffer_load_dwordx4 v[92:95], v2, s[64:67], s7 offen
    s_add_u32 s7, s8, 114688
    buffer_load_dwordx4 v[96:99], v2, s[60:63], s7 offen
    buffer_load_dwordx4 v[100:103], v2, s[64:67], s7 offen
    s_add_u32 s7, s8, 129024
    buffer_load_dwordx4 v[104:107], v2, s[60:63], s7 offen
    buffer_load_dwordx4 v[108:111], v2, s[64:67], s7 offen
    s_add_u32 s7, s8, 143360
    buffer_load_dwordx4 v[112:115], v2, s[60:63], s7 offen
    buffer_load_dwordx4 v[116:119], v2, s[64:67], s7 offen
    s_add_u32 s7, s8, 157696
    buffer_load_dwordx4 v[120:123], v2, s[60:63], s7 offen
    buffer_load_dwordx4 v[124:127], v2, s[64:67], s7 offen
    s_add_u32 s7, s8, 172032
    buffer_load_dwordx4 v[128:131], v2, s[60:63], s7 offen
    buffer_load_dwordx4 v[132:135], v2, s[64:67], s7 offen
    s_add_u32 s7, s8, 186368
    buffer_load_dwordx4 v[136:139], v2, s[60:63], s7 offen
    buffer_load_dwordx4 v[140:143], v2, s[64:67], s7 offen
    s_add_u32 s7, s8, 200704
    buffer_load_dwordx4 v[144:147], v2, s[60:63], s7 offen
    buffer_load_dwordx4 v[148:151], v2, s[64:67], s7 offen
    s_add_u32 s7, s8, 215040
    buffer_load_dwordx4 v[152:155], v2, s[60:63], s7 offen
    buffer_load_dwordx4 v[156:159], v2, s[64:67], s7 offen
    s_add_u32 s7, s8, 229376
    buffer_load_dwordx4 v[160:163], v2, s[60:63], s7 offen
    buffer_load_dwordx4 v[164:167], v2, s[64:67], s7 offen
    s_add_u32 s7, s8, 243712
    buffer_load_dwordx4 v[168:171], v2, s[60:63], s7 offen
    buffer_load_dwordx4 v[172:175], v2, s[64:67], s7 offen
    s_add_u32 s7, s8, 258048
    buffer_load_dwordx4 v[176:179], v2, s[60:63], s7 offen
    buffer_load_dwordx4 v[180:183], v2, s[64:67], s7 offen
    s_add_u32 s7, s8, 272384
    buffer_load_dwordx4 v[184:187], v2, s[60:63], s7 offen
    buffer_load_dwordx4 v[188:191], v2, s[64:67], s7 offen
    s_add_u32 s7, s8, 286720
    buffer_load_dwordx4 v[192:195], v2, s[60:63], s7 offen
    buffer_load_dwordx4 v[196:199], v2, s[64:67], s7 offen
    s_add_u32 s7, s8, 301056
    buffer_load_dwordx4 v[200:203], v2, s[60:63], s7 offen
    buffer_load_dwordx4 v[204:207], v2, s[64:67], s7 offen
    s_add_u32 s7, s8, 315392
    buffer_load_dwordx4 v[208:211], v2, s[60:63], s7 offen
    buffer_load_dwordx4 v[212:215], v2, s[64:67], s7 offen
    s_add_u32 s7, s8, 329728
    buffer_load_dwordx4 v[216:219], v2, s[60:63], s7 offen
    buffer_load_dwordx4 v[220:223], v2, s[64:67], s7 offen
    s_add_u32 s7, s8, 344064
    buffer_load_dwordx4 v[224:227], v2, s[60:63], s7 offen
    buffer_load_dwordx4 v[228:231], v2, s[64:67], s7 offen
    s_add_u32 s7, s8, 358400
    buffer_load_dwordx4 v[232:235], v2, s[60:63], s7 offen
    buffer_load_dwordx4 v[236:239], v2, s[64:67], s7 offen
    s_add_u32 s7, s8, 372736
    buffer_load_dwordx4 v[240:243], v2, s[60:63], s7 offen
    buffer_load_dwordx4 v[244:247], v2, s[64:67], s7 offen
    s_add_u32 s7, s8, 387072
    buffer_load_dwordx4 v[248:251], v2, s[60:63], s7 offen
    buffer_load_dwordx4 v[252:255], v2, s[64:67], s7 offen
    s_mul_i32 s8, s2, 100352
    s_lshl_b32 s7, s3, 8
    s_add_u32 s8, s8, s7
    s_lshl_b32 s9, s3, 11
    s_cmp_eq_u32 s3, 3
    s_cbranch_scc1 L_SVD3
    s_add_u32 m0, s9, 1024
    s_add_u32 s7, s8, 128
    buffer_load_dwordx4 v1, s[68:71], s7 offen nt lds
    s_add_u32 m0, s9, 8192
    s_add_u32 s7, s8, 7296
    buffer_load_dwordx4 v1, s[68:71], s7 offen nt lds
    s_add_u32 m0, s9, 15360
    s_add_u32 s7, s8, 14464
    buffer_load_dwordx4 v1, s[68:71], s7 offen nt lds
    s_add_u32 m0, s9, 22528
    s_add_u32 s7, s8, 21632
    buffer_load_dwordx4 v1, s[68:71], s7 offen nt lds
    s_add_u32 m0, s9, 29696
    s_add_u32 s7, s8, 28800
    buffer_load_dwordx4 v1, s[68:71], s7 offen nt lds
    s_add_u32 m0, s9, 36864
    s_add_u32 s7, s8, 35968
    buffer_load_dwordx4 v1, s[68:71], s7 offen nt lds
    s_add_u32 m0, s9, 44032
    s_add_u32 s7, s8, 43136
    buffer_load_dwordx4 v1, s[68:71], s7 offen nt lds
    s_add_u32 m0, s9, 51200
    s_add_u32 s7, s8, 50304
    buffer_load_dwordx4 v1, s[68:71], s7 offen nt lds
    s_add_u32 m0, s9, 58368
    s_add_u32 s7, s8, 57472
    buffer_load_dwordx4 v1, s[68:71], s7 offen nt lds
    s_add_u32 m0, s9, 65536
    s_add_u32 s7, s8, 64640
    buffer_load_dwordx4 v1, s[68:71], s7 offen nt lds
    s_add_u32 m0, s9, 72704
    s_add_u32 s7, s8, 71808
    buffer_load_dwordx4 v1, s[68:71], s7 offen nt lds
    s_add_u32 m0, s9, 79872
    s_add_u32 s7, s8, 78976
    buffer_load_dwordx4 v1, s[68:71], s7 offen nt lds
    s_add_u32 m0, s9, 87040
    s_add_u32 s7, s8, 86144
    buffer_load_dwordx4 v1, s[68:71], s7 offen nt lds
    s_add_u32 m0, s9, 94208
    s_add_u32 s7, s8, 93312
    buffer_load_dwordx4 v1, s[68:71], s7 offen nt lds
L_SVD3:
    s_add_u32 m0, s9, 0
    s_add_u32 s7, s8, 0
    buffer_load_dwordx4 v1, s[68:71], s7 offen nt lds
    s_add_u32 m0, s9, 7168
    s_add_u32 s7, s8, 7168
    buffer_load_dwordx4 v1, s[68:71], s7 offen nt lds
    s_add_u32 m0, s9, 14336
    s_add_u32 s7, s8, 14336
    buffer_load_dwordx4 v1, s[68:71], s7 offen nt lds
    s_add_u32 m0, s9, 21504
    s_add_u32 s7, s8, 21504
    buffer_load_dwordx4 v1, s[68:71], s7 offen nt lds
    s_add_u32 m0, s9, 28672
    s_add_u32 s7, s8, 28672
    buffer_load_dwordx4 v1, s[68:71], s7 offen nt lds
    s_add_u32 m0, s9, 35840
    s_add_u32 s7, s8, 35840
    buffer_load_dwordx4 v1, s[68:71], s7 offen nt lds
    s_add_u32 m0, s9, 43008
    s_add_u32 s7, s8, 43008
    buffer_load_dwordx4 v1, s[68:71], s7 offen nt lds
    s_add_u32 m0, s9, 50176
    s_add_u32 s7, s8, 50176
    buffer_load_dwordx4 v1, s[68:71], s7 offen nt lds
    s_add_u32 m0, s9, 57344
    s_add_u32 s7, s8, 57344
    buffer_load_dwordx4 v1, s[68:71], s7 offen nt lds
    s_add_u32 m0, s9, 64512
    s_add_u32 s7, s8, 64512
    buffer_load_dwordx4 v1, s[68:71], s7 offen nt lds
    s_add_u32 m0, s9, 71680
    s_add_u32 s7, s8, 71680
    buffer_load_dwordx4 v1, s[68:71], s7 offen nt lds
    s_add_u32 m0, s9, 78848
    s_add_u32 s7, s8, 78848
    buffer_load_dwordx4 v1, s[68:71], s7 offen nt lds
    s_add_u32 m0, s9, 86016
    s_add_u32 s7, s8, 86016
    buffer_load_dwordx4 v1, s[68:71], s7 offen nt lds
    s_add_u32 m0, s9, 93184
    s_add_u32 s7, s8, 93184
    buffer_load_dwordx4 v1, s[68:71], s7 offen nt lds
    v_and_b32 v29, 15, v0
    v_lshlrev_b32 v29, 2, v29
L_SVFL:
    buffer_load_dword v28, v29, s[52:55], 0 offen offset:128 sc1
    s_waitcnt vmcnt(0)
    v_cmp_eq_u32 vcc, 0, v28
    s_cbranch_vccz L_SVLOOP
    s_sleep 2
    s_sub_u32 s96, s96, 1
    s_cmp_eq_u32 s96, 0
    s_cbranch_scc1 L_END
    s_branch L_SVFL
L_SVLOOP:
    s_and_b32 s5, s4, 1
    s_mul_i32 s5, s5, 1792
    s_sub_u32 s8, s4, 2
    s_mul_i32 s8, s8, 17280
    s_add_u32 s8, s8, s6
    s_add_u32 s8, s8, 16640
L_WG0:
    buffer_load_dwordx2 v[44:45], v14, s[48:51], s8 offen sc1
    s_waitcnt vmcnt(0)
    v_cmp_ne_u32 vcc, -1, v44
    s_and_b32 s7, vcc_lo, 0x7fff
    s_bcnt1_i32_b32 s7, s7
    s_cmp_ge_u32 s7, 6
    s_cbranch_scc1 L_WG
    s_sleep 2
    s_sub_u32 s96, s96, 1
    s_cmp_eq_u32 s96, 0
    s_cbranch_scc1 L_END
    s_branch L_WG0
L_WG:
    buffer_load_dwordx2 v[44:45], v14, s[48:51], s8 offen sc1
    s_add_u32 s7, s8, 0
    buffer_load_dword v28, v13, s[48:51], s7 offen sc1
    s_add_u32 s7, s8, 1152
    buffer_load_dword v29, v13, s[48:51], s7 offen sc1
    s_add_u32 s7, s8, 2304
    buffer_load_dword v30, v13, s[48:51], s7 offen sc1
    s_add_u32 s7, s8, 3456
    buffer_load_dword v31, v13, s[48:51], s7 offen sc1
    s_add_u32 s7, s8, 4608
    buffer_load_dword v32, v13, s[48:51], s7 offen sc1
    s_add_u32 s7, s8, 5760
    buffer_load_dword v33, v13, s[48:51], s7 offen sc1
    s_add_u32 s7, s8, 6912
    buffer_load_dword v34, v13, s[48:51], s7 offen sc1
    s_add_u32 s7, s8, 8064
    buffer_load_dword v35, v13, s[48:51], s7 offen sc1
    s_add_u32 s7, s8, 9216
    buffer_load_dword v36, v13, s[48:51], s7 offen sc1
    s_add_u32 s7, s8, 10368
    buffer_load_dword v37, v13, s[48:51], s7 offen sc1
    s_add_u32 s7, s8, 11520
    buffer_load_dword v38, v13, s[48:51], s7 offen sc1
    s_add_u32 s7, s8, 12672
    buffer_load_dword v39, v13, s[48:51], s7 offen sc1
    s_add_u32 s7, s8, 13824
    buffer_load_dword v40, v13, s[48:51], s7 offen sc1
    s_add_u32 s7, s8, 14976
    buffer_load_dword v41, v13, s[48:51], s7 offen sc1
    s_add_u32 s7, s8, 16128
    buffer_load_dword v42, v13, s[48:51], s7 offen sc1
    s_waitcnt vmcnt(0)
    v_max_u32 v46, v28, v29
    v_max3_u32 v46, v46, v30, v31
    v_max3_u32 v46, v46, v32, v33
    v_max3_u32 v46, v46, v34, v35
    v_max3_u32 v46, v46, v36, v37
    v_max3_u32 v46, v46, v38, v39
    v_max3_u32 v46, v46, v40, v41
    v_max3_u32 v46, v46, v42, v44
    v_max_u32 v46, v46, v45
    v_cmp_eq_u32 vcc, -1, v46
    s_cbranch_vccz L_WGOK
    s_sleep 2
    s_sub_u32 s96, s96, 1
    s_cmp_eq_u32 s96, 0
    s_cbranch_scc1 L_END
    s_branch L_WG
L_WGOK:
    v_mov_b32 v46, v44
    v_and_b32 v47, 15, v0
    v_cmp_gt_u32 vcc, 15, v47
    s_nop 1
    v_max_f32_dpp v46, v46, v46 quad_perm:[1,0,3,2] row_mask:0xf bank_mask:0xf
    s_nop 1
    v_max_f32_dpp v46, v46, v46 quad_perm:[2,3,0,1] row_mask:0xf bank_mask:0xf
    s_nop 1
    v_max_f32_dpp v46, v46, v46 row_half_mirror row_mask:0xf bank_mask:0xf
    s_nop 1
    v_max_f32_dpp v46, v46, v46 row_mirror row_mask:0xf bank_mask:0xf
    v_sub_f32 v44, v44, v46
    v_exp_f32 v44, v44
    v_cndmask_b32 v45, 0, v45, vcc
    v_mov_b32 v46, 0
    v_mov_b32 v47, 0
    v_mov_b32 v48, 0
    v_mul_f32 v45, v44, v45
    s_nop 0
    v_fmac_f32_dpp v46, v44, v28 row_newbcast:0 row_mask:0xf bank_mask:0xf
    v_fmac_f32_dpp v47, v44, v29 row_newbcast:1 row_mask:0xf bank_mask:0xf
    v_add_f32_dpp v45, v45, v45 quad_perm:[1,0,3,2] row_mask:0xf bank_mask:0xf
    v_fmac_f32_dpp v48, v44, v30 row_newbcast:2 row_mask:0xf bank_mask:0xf
    v_fmac_f32_dpp v46, v44, v31 row_newbcast:3 row_mask:0xf bank_mask:0xf
    v_fmac_f32_dpp v47, v44, v32 row_newbcast:4 row_mask:0xf bank_mask:0xf
    v_add_f32_dpp v45, v45, v45 quad_perm:[2,3,0,1] row_mask:0xf bank_mask:0xf
    v_fmac_f32_dpp v48, v44, v33 row_newbcast:5 row_mask:0xf bank_mask:0xf
    v_fmac_f32_dpp v46, v44, v34 row_newbcast:6 row_mask:0xf bank_mask:0xf
    v_fmac_f32_dpp v47, v44, v35 row_newbcast:7 row_mask:0xf bank_mask:0xf
    v_add_f32_dpp v45, v45, v45 row_half_mirror row_mask:0xf bank_mask:0xf
    v_fmac_f32_dpp v48, v44, v36 row_newbcast:8 row_mask:0xf bank_mask:0xf
    v_fmac_f32_dpp v46, v44, v37 row_newbcast:9 row_mask:0xf bank_mask:0xf
    v_fmac_f32_dpp v47, v44, v38 row_newbcast:10 row_mask:0xf bank_mask:0xf
    v_add_f32_dpp v45, v45, v45 row_mirror row_mask:0xf bank_mask:0xf
    v_fmac_f32_dpp v48, v44, v39 row_newbcast:11 row_mask:0xf bank_mask:0xf
    v_fmac_f32_dpp v46, v44, v40 row_newbcast:12 row_mask:0xf bank_mask:0xf
    v_rcp_f32 v45, v45
    v_fmac_f32_dpp v47, v44, v41 row_newbcast:13 row_mask:0xf bank_mask:0xf
    v_fmac_f32_dpp v48, v44, v42 row_newbcast:14 row_mask:0xf bank_mask:0xf
    v_add_f32 v46, v46, v47
    v_add_f32 v46, v46, v48
    v_mul_f32 v46, v46, v45
    v_cvt_pk_bf16_f32 v58, v46, v46
    s_nop 1
    v_mov_b32_dpp v56, v58 row_newbcast:0 row_mask:0xf bank_mask:0xf
    v_mov_b32_dpp v57, v58 row_newbcast:8 row_mask:0xf bank_mask:0xf
    v_cndmask_b32 v56, v56, v57, s[12:13]
    v_and_b32 v24, v56, v4
    v_and_b32 v25, v56, v5
    v_and_b32 v26, v56, v6
    v_and_b32 v27, v56, v7
    s_nop 1
    v_mfma_f32_16x16x32_bf16 v[28:31], a[0:3], v[24:27], 0
    v_mov_b32_dpp v56, v58 row_newbcast:1 row_mask:0xf bank_mask:0xf
    v_mov_b32_dpp v57, v58 row_newbcast:9 row_mask:0xf bank_mask:0xf
    v_mfma_f32_16x16x32_bf16 v[32:35], a[4:7], v[24:27], 0
    v_cndmask_b32 v56, v56, v57, s[12:13]
    v_and_b32 v60, v56, v4
    v_mfma_f32_16x16x32_bf16 v[36:39], a[8:11], v[24:27], 0
    v_and_b32 v61, v56, v5
    v_and_b32 v62, v56, v6
    v_mfma_f32_16x16x32_bf16 v[40:43], a[12:15], v[24:27], 0
    v_and_b32 v63, v56, v7
    v_mfma_f32_16x16x32_bf16 v[44:47], a[16:19], v[24:27], 0
    v_mfma_f32_16x16x32_bf16 v[48:51], a[20:23], v[24:27], 0
    v_mfma_f32_16x16x32_bf16 v[52:55], a[24:27], v[24:27], 0
    v_mfma_f32_16x16x32_bf16 v[28:31], a[28:31], v[60:63], v[28:31]
    v_mov_b32_dpp v56, v58 row_newbcast:2 row_mask:0xf bank_mask:0xf
    v_mov_b32_dpp v57, v58 row_newbcast:10 row_mask:0xf bank_mask:0xf
    v_mfma_f32_16x16x32_bf16 v[32:35], a[32:35], v[60:63], v[32:35]
    v_cndmask_b32 v56, v56, v57, s[12:13]
    v_and_b32 v24, v56, v4
    v_mfma_f32_16x16x32_bf16 v[36:39], a[36:39], v[60:63], v[36:39]
    v_and_b32 v25, v56, v5
    v_and_b32 v26, v56, v6
    v_mfma_f32_16x16x32_bf16 v[40:43], a[40:43], v[60:63], v[40:43]
    v_and_b32 v27, v56, v7
    v_mfma_f32_16x16x32_bf16 v[44:47], a[44:47], v[60:63], v[44:47]
    v_mfma_f32_16x16x32_bf16 v[48:51], a[48:51], v[60:63], v[48:51]
    v_mfma_f32_16x16x32_bf16 v[52:55], a[52:55], v[60:63], v[52:55]
    v_mfma_f32_16x16x32_bf16 v[28:31], a[56:59], v[24:27], v[28:31]
    v_mov_b32_dpp v56, v58 row_newbcast:3 row_mask:0xf bank_mask:0xf
    v_mov_b32_dpp v57, v58 row_newbcast:11 row_mask:0xf bank_mask:0xf
    v_mfma_f32_16x16x32_bf16 v[32:35], a[60:63], v[24:27], v[32:35]
    v_cndmask_b32 v56, v56, v57, s[12:13]
    v_and_b32 v60, v56, v4
    v_mfma_f32_16x16x32_bf16 v[36:39], a[64:67], v[24:27], v[36:39]
    v_and_b32 v61, v56, v5
    v_and_b32 v62, v56, v6
    v_mfma_f32_16x16x32_bf16 v[40:43], a[68:71], v[24:27], v[40:43]
    v_and_b32 v63, v56, v7
    v_mfma_f32_16x16x32_bf16 v[44:47], a[72:75], v[24:27], v[44:47]
    v_mfma_f32_16x16x32_bf16 v[48:51], a[76:79], v[24:27], v[48:51]
    v_mfma_f32_16x16x32_bf16 v[52:55], a[80:83], v[24:27], v[52:55]
    v_mfma_f32_16x16x32_bf16 v[28:31], a[84:87], v[60:63], v[28:31]
    v_mov_b32_dpp v56, v58 row_newbcast:4 row_mask:0xf bank_mask:0xf
    v_mov_b32_dpp v57, v58 row_newbcast:12 row_mask:0xf bank_mask:0xf
    v_mfma_f32_16x16x32_bf16 v[32:35], a[88:91], v[60:63], v[32:35]
    v_cndmask_b32 v56, v56, v57, s[12:13]
    v_and_b32 v24, v56, v4
    v_mfma_f32_16x16x32_bf16 v[36:39], a[92:95], v[60:63], v[36:39]
    v_and_b32 v25, v56, v5
    v_and_b32 v26, v56, v6
    v_mfma_f32_16x16x32_bf16 v[40:43], a[96:99], v[60:63], v[40:43]
    v_and_b32 v27, v56, v7
    v_mfma_f32_16x16x32_bf16 v[44:47], a[100:103], v[60:63], v[44:47]
    v_mfma_f32_16x16x32_bf16 v[48:51], a[104:107], v[60:63], v[48:51]
    v_mfma_f32_16x16x32_bf16 v[52:55], a[108:111], v[60:63], v[52:55]
    v_mfma_f32_16x16x32_bf16 v[28:31], a[112:115], v[24:27], v[28:31]
    v_mov_b32_dpp v56, v58 row_newbcast:5 row_mask:0xf bank_mask:0xf
    v_mov_b32_dpp v57, v58 row_newbcast:13 row_mask:0xf bank_mask:0xf
    v_mfma_f32_16x16x32_bf16 v[32:35], a[116:119], v[24:27], v[32:35]
    v_cndmask_b32 v56, v56, v57, s[12:13]
    v_and_b32 v60, v56, v4
    v_mfma_f32_16x16x32_bf16 v[36:39], a[120:123], v[24:27], v[36:39]
    v_and_b32 v61, v56, v5
    v_and_b32 v62, v56, v6
    v_mfma_f32_16x16x32_bf16 v[40:43], a[124:127], v[24:27], v[40:43]
    v_and_b32 v63, v56, v7
    v_mfma_f32_16x16x32_bf16 v[44:47], a[128:131], v[24:27], v[44:47]
    v_mfma_f32_16x16x32_bf16 v[48:51], a[132:135], v[24:27], v[48:51]
    v_mfma_f32_16x16x32_bf16 v[52:55], a[136:139], v[24:27], v[52:55]
    v_mfma_f32_16x16x32_bf16 v[28:31], a[140:143], v[60:63], v[28:31]
    v_mov_b32_dpp v56, v58 row_newbcast:6 row_mask:0xf bank_mask:0xf
    v_mov_b32_dpp v57, v58 row_newbcast:14 row_mask:0xf bank_mask:0xf
    v_mfma_f32_16x16x32_bf16 v[32:35], a[144:147], v[60:63], v[32:35]
    v_cndmask_b32 v56, v56, v57, s[12:13]
    v_and_b32 v24, v56, v4
    v_mfma_f32_16x16x32_bf16 v[36:39], a[148:151], v[60:63], v[36:39]
    v_and_b32 v25, v56, v5
    v_and_b32 v26, v56, v6
    v_mfma_f32_16x16x32_bf16 v[40:43], a[152:155], v[60:63], v[40:43]
    v_and_b32 v27, v56, v7
    v_mfma_f32_16x16x32_bf16 v[44:47], a[156:159], v[60:63], v[44:47]
    v_mfma_f32_16x16x32_bf16 v[48:51], a[160:163], v[60:63], v[48:51]
    v_mfma_f32_16x16x32_bf16 v[52:55], a[164:167], v[60:63], v[52:55]
    v_mfma_f32_16x16x32_bf16 v[28:31], a[168:171], v[24:27], v[28:31]
    v_mov_b32_dpp v56, v58 row_newbcast:7 row_mask:0xf bank_mask:0xf
    v_mov_b32_dpp v57, v58 row_newbcast:15 row_mask:0xf bank_mask:0xf
    v_mfma_f32_16x16x32_bf16 v[32:35], a[172:175], v[24:27], v[32:35]
    v_cndmask_b32 v56, v56, v57, s[12:13]
    v_and_b32 v60, v56, v4
    v_mfma_f32_16x16x32_bf16 v[36:39], a[176:179], v[24:27], v[36:39]
    v_and_b32 v61, v56, v5
    v_and_b32 v62, v56, v6
    v_mfma_f32_16x16x32_bf16 v[40:43], a[180:183], v[24:27], v[40:43]
    v_and_b32 v63, v56, v7
    v_mfma_f32_16x16x32_bf16 v[44:47], a[184:187], v[24:27], v[44:47]
    v_mfma_f32_16x16x32_bf16 v[48:51], a[188:191], v[24:27], v[48:51]
    v_mfma_f32_16x16x32_bf16 v[52:55], a[192:195], v[24:27], v[52:55]
    v_mfma_f32_16x16x32_bf16 v[28:31], a[196:199], v[60:63], v[28:31]
    v_mfma_f32_16x16x32_bf16 v[32:35], a[200:203], v[60:63], v[32:35]
    v_mfma_f32_16x16x32_bf16 v[36:39], a[204:207], v[60:63], v[36:39]
    v_mfma_f32_16x16x32_bf16 v[40:43], a[208:211], v[60:63], v[40:43]
    v_mfma_f32_16x16x32_bf16 v[44:47], a[212:215], v[60:63], v[44:47]
    v_mfma_f32_16x16x32_bf16 v[48:51], a[216:219], v[60:63], v[48:51]
    v_mfma_f32_16x16x32_bf16 v[52:55], a[220:223], v[60:63], v[52:55]
    s_nop 7
    s_mov_b32 exec_lo, 0xff00ff
    s_mov_b32 exec_hi, 0xff00ff00
    ds_write_b128 v15, v[28:31] offset:0
    ds_write_b128 v15, v[32:35] offset:256
    ds_write_b128 v15, v[36:39] offset:512
    ds_write_b128 v15, v[40:43] offset:768
    ds_write_b128 v15, v[44:47] offset:1024
    ds_write_b128 v15, v[48:51] offset:1280
    ds_write_b128 v15, v[52:55] offset:1536
    s_mov_b64 exec, -1
    s_waitcnt lgkmcnt(0)
    s_barrier
    s_mov_b32 exec_lo, 0xffffffff
    s_mov_b32 exec_hi, 0xffffff
    v_add_u32 v44, 144896, v12
    ds_read_b64 v[28:29], v44 offset:0
    ds_read_b64 v[30:31], v44 offset:1792
    ds_read_b64 v[32:33], v44 offset:3584
    ds_read_b64 v[34:35], v44 offset:5376
    ds_read_b64 v[36:37], v44 offset:7168
    ds_read_b64 v[38:39], v44 offset:8960
    ds_read_b64 v[40:41], v44 offset:10752
    ds_read_b64 v[42:43], v44 offset:12544
    s_sub_u32 s8, s4, 2
    s_mul_i32 s8, s8, 1792
    s_add_u32 s8, s8, s6
    s_waitcnt lgkmcnt(0)
    v_add_f32 v28, v28, v30
    v_add_f32 v29, v29, v31
    v_add_f32 v28, v28, v32
    v_add_f32 v29, v29, v33
    v_add_f32 v28, v28, v34
    v_add_f32 v29, v29, v35
    v_add_f32 v28, v28, v36
    v_add_f32 v29, v29, v37
    v_add_f32 v28, v28, v38
    v_add_f32 v29, v29, v39
    v_add_f32 v28, v28, v40
    v_add_f32 v29, v29, v41
    v_add_f32 v28, v28, v42
    v_add_f32 v29, v29, v43
    v_min_u32 v28, -2, v28
    v_min_u32 v29, -2, v29
    buffer_store_dwordx2 v[28:29], v12, s[48:51], s8 offen offset:2304 sc1
    s_mov_b64 exec, -1
    s_add_u32 s5, s5, 141312
    s_mov_b32 exec_lo, 0xffffffff
    s_mov_b32 exec_hi, 0xffffff
    s_sub_u32 s8, s4, 2
    s_mul_i32 s8, s8, 1792
    s_add_u32 s8, s8, 2304
    v_add_u32 v62, s5, v12
    ds_read_b64 v[60:61], v62 offset:0
L_GY:
    s_add_u32 s7, s8, 0
    buffer_load_dwordx2 v[28:29], v12, s[48:51], s7 offen offset:0 sc1
    s_add_u32 s7, s8, 98304
    buffer_load_dwordx2 v[30:31], v12, s[48:51], s7 offen offset:0 sc1
    s_add_u32 s7, s8, 196608
    buffer_load_dwordx2 v[32:33], v12, s[48:51], s7 offen offset:0 sc1
    s_add_u32 s7, s8, 294912
    buffer_load_dwordx2 v[34:35], v12, s[48:51], s7 offen offset:0 sc1
    s_add_u32 s7, s8, 393216
    buffer_load_dwordx2 v[36:37], v12, s[48:51], s7 offen offset:0 sc1
    s_add_u32 s7, s8, 491520
    buffer_load_dwordx2 v[38:39], v12, s[48:51], s7 offen offset:0 sc1
    s_add_u32 s7, s8, 589824
    buffer_load_dwordx2 v[40:41], v12, s[48:51], s7 offen offset:0 sc1
    s_add_u32 s7, s8, 688128
    buffer_load_dwordx2 v[42:43], v12, s[48:51], s7 offen offset:0 sc1
    s_add_u32 s7, s8, 786432
    buffer_load_dwordx2 v[44:45], v12, s[48:51], s7 offen offset:0 sc1
    s_add_u32 s7, s8, 884736
    buffer_load_dwordx2 v[46:47], v12, s[48:51], s7 offen offset:0 sc1
    s_add_u32 s7, s8, 983040
    buffer_load_dwordx2 v[48:49], v12, s[48:51], s7 offen offset:0 sc1
    s_add_u32 s7, s8, 1081344
    buffer_load_dwordx2 v[50:51], v12, s[48:51], s7 offen offset:0 sc1
    s_add_u32 s7, s8, 1179648
    buffer_load_dwordx2 v[52:53], v12, s[48:51], s7 offen offset:0 sc1
    s_add_u32 s7, s8, 1277952
    buffer_load_dwordx2 v[54:55], v12, s[48:51], s7 offen offset:0 sc1
    s_add_u32 s7, s8, 1376256
    buffer_load_dwordx2 v[56:57], v12, s[48:51], s7 offen offset:0 sc1
    s_add_u32 s7, s8, 1474560
    buffer_load_dwordx2 v[58:59], v12, s[48:51], s7 offen offset:0 sc1
    s_waitcnt vmcnt(0)
    v_max_u32 v63, v28, v29
    v_max3_u32 v63, v63, v30, v31
    v_max3_u32 v63, v63, v32, v33
    v_max3_u32 v63, v63, v34, v35
    v_max3_u32 v63, v63, v36, v37
    v_max3_u32 v63, v63, v38, v39
    v_max3_u32 v63, v63, v40, v41
    v_max3_u32 v63, v63, v42, v43
    v_max3_u32 v63, v63, v44, v45
    v_max3_u32 v63, v63, v46, v47
    v_max3_u32 v63, v63, v48, v49
    v_max3_u32 v63, v63, v50, v51
    v_max3_u32 v63, v63, v52, v53
    v_max3_u32 v63, v63, v54, v55
    v_max3_u32 v63, v63, v56, v57
    v_max3_u32 v63, v63, v58, v59
    v_cmp_eq_u32 vcc, -1, v63
    s_cbranch_vccz L_GYOK
    s_sleep 2
    s_sub_u32 s96, s96, 1
    s_cmp_eq_u32 s96, 0
    s_cbranch_scc1 L_END
    s_branch L_GY
L_GYOK:
    v_add_f32 v28, v28, v30
    v_add_f32 v29, v29, v31
    v_add_f32 v28, v28, v32
    v_add_f32 v29, v29, v33
    v_add_f32 v28, v28, v34
    v_add_f32 v29, v29, v35
    v_add_f32 v28, v28, v36
    v_add_f32 v29, v29, v37
    v_add_f32 v28, v28, v38
    v_add_f32 v29, v29, v39
    v_add_f32 v28, v28, v40
    v_add_f32 v29, v29, v41
    v_add_f32 v28, v28, v42
    v_add_f32 v29, v29, v43
    v_add_f32 v28, v28, v44
    v_add_f32 v29, v29, v45
    v_add_f32 v28, v28, v46
    v_add_f32 v29, v29, v47
    v_add_f32 v28, v28, v48
    v_add_f32 v29, v29, v49
    v_add_f32 v28, v28, v50
    v_add_f32 v29, v29, v51
    v_add_f32 v28, v28, v52
    v_add_f32 v29, v29, v53
    v_add_f32 v28, v28, v54
    v_add_f32 v29, v29, v55
    v_add_f32 v28, v28, v56
    v_add_f32 v29, v29, v57
    v_add_f32 v28, v28, v58
    v_add_f32 v29, v29, v59
    v_cvt_pk_bf16_f32 v28, v28, v28
    v_and_b32 v28, 0xffff0000, v28
    v_cvt_pk_bf16_f32 v29, v29, v29
    v_and_b32 v29, 0xffff0000, v29
    s_waitcnt lgkmcnt(0)
    v_add_f32 v28, v28, v60
    v_add_f32 v29, v29, v61
    v_cvt_pk_bf16_f32 v28, v28, v28
    v_and_b32 v28, 0xffff0000, v28
    v_cvt_pk_bf16_f32 v29, v29, v29
    v_and_b32 v29, 0xffff0000, v29
    ds_write_b64 v62, v[28:29]
    s_mov_b64 exec, -1
    s_sub_u32 s5, s5, 141312
    s_waitcnt lgkmcnt(0)
    s_barrier
    v_add_u32 v38, s5, v21
    v_add_u32 v39, s5, v16
    s_add_u32 s7, s5, 141312
    v_mov_b32 v37, s7
    ds_read_b32 v37, v37
    ds_read2st64_b32 v[28:29], v38 offset0:0 offset1:1
    ds_read2st64_b32 v[30:31], v38 offset0:2 offset1:3
    ds_read2st64_b32 v[32:33], v38 offset0:4 offset1:5
    ds_read_b32 v34, v38 offset:1536
    ds_read_b32 v40, v39
    ds_read_b32 v41, v39 offset:256
    s_waitcnt lgkmcnt(2)
    v_sub_f32 v28, v28, v37
    v_sub_f32 v29, v29, v37
    v_sub_f32 v30, v30, v37
    v_sub_f32 v31, v31, v37
    v_sub_f32 v32, v32, v37
    v_sub_f32 v33, v33, v37
    v_sub_f32 v34, v34, v37
    v_add_f32 v36, v28, v29
    v_mul_f32 v35, v28, v28
    v_fmac_f32 v35, v29, v29
    v_fmac_f32 v35, v30, v30
    v_add_f32 v36, v36, v30
    v_fmac_f32 v35, v31, v31
    v_add_f32 v36, v36, v31
    v_fmac_f32 v35, v32, v32
    v_add_f32 v36, v36, v32
    v_fmac_f32 v35, v33, v33
    v_add_f32 v36, v36, v33
    v_fmac_f32 v35, v34, v34
    v_add_f32 v36, v36, v34
    s_nop 0
    s_nop 0
    v_add_f32_dpp v36, v36, v36 quad_perm:[1,0,3,2] row_mask:0xf bank_mask:0xf
    v_add_f32_dpp v35, v35, v35 quad_perm:[1,0,3,2] row_mask:0xf bank_mask:0xf
    s_nop 0
    v_add_f32_dpp v36, v36, v36 quad_perm:[2,3,0,1] row_mask:0xf bank_mask:0xf
    v_add_f32_dpp v35, v35, v35 quad_perm:[2,3,0,1] row_mask:0xf bank_mask:0xf
    s_nop 0
    v_add_f32_dpp v36, v36, v36 row_half_mirror row_mask:0xf bank_mask:0xf
    v_add_f32_dpp v35, v35, v35 row_half_mirror row_mask:0xf bank_mask:0xf
    s_nop 0
    v_add_f32_dpp v36, v36, v36 row_mirror row_mask:0xf bank_mask:0xf
    v_add_f32_dpp v35, v35, v35 row_mirror row_mask:0xf bank_mask:0xf
    v_mov_b32 v38, v36
    v_mov_b32 v39, v35
    s_nop 0
    v_permlane16_swap_b32 v36, v38
    v_permlane16_swap_b32 v35, v39
    v_add_f32 v36, v36, v38
    v_add_f32 v35, v35, v39
    v_mov_b32 v38, v36
    v_mov_b32 v39, v35
    s_nop 0
    v_permlane32_swap_b32 v36, v38
    v_permlane32_swap_b32 v35, v39
    v_add_f32 v36, v36, v38
    v_add_f32 v35, v35, v39
    v_mul_f32 v36, 0x3b124925, v36
    v_mul_f32 v35, 0x3b124925, v35
    v_fma_f32 v35, -v36, v36, v35
    v_add_f32 v36, v36, v37
    v_max_f32 v35, 0, v35
    v_cvt_pk_bf16_f32 v36, v36, v36
    v_and_b32 v36, 0xffff0000, v36
    v_cvt_pk_bf16_f32 v35, v35, v35
    v_and_b32 v35, 0xffff0000, v35
    s_waitcnt lgkmcnt(0)
    v_add_f32 v35, 0x3727c5ac, v35
    v_sub_f32 v40, v40, v36
    v_sub_f32 v41, v41, v36
    v_cvt_pk_bf16_f32 v35, v35, v35
    v_and_b32 v35, 0xffff0000, v35
    v_sqrt_f32 v35, v35
    v_cvt_pk_bf16_f32 v40, v40, v40
    v_and_b32 v40, 0xffff0000, v40
    v_cvt_pk_bf16_f32 v41, v41, v41
    v_and_b32 v41, 0xffff0000, v41
    v_cvt_pk_bf16_f32 v35, v35, v35
    v_and_b32 v35, 0xffff0000, v35
    v_rcp_f32 v35, v35
    s_nop 0
    v_mul_f32 v40, v40, v35
    v_mul_f32 v41, v41, v35
    v_cvt_pk_bf16_f32 v40, v40, v40
    v_cvt_pk_bf16_f32 v41, v41, v41
    s_nop 0
    v_and_b32_dpp v24, v40, v8 row_newbcast:0 row_mask:0xf bank_mask:0xf
    v_and_b32_dpp v25, v40, v9 row_newbcast:0 row_mask:0xf bank_mask:0xf
    v_and_b32_dpp v26, v40, v10 row_newbcast:0 row_mask:0xf bank_mask:0xf
    v_and_b32_dpp v27, v40, v11 row_newbcast:0 row_mask:0xf bank_mask:0xf
    s_nop 0
    s_nop 0
    v_mfma_f32_16x16x32_bf16 v[44:47], a[224:227], v[24:27], 0
    v_and_b32_dpp v52, v40, v8 row_newbcast:1 row_mask:0xf bank_mask:0xf
    v_and_b32_dpp v53, v40, v9 row_newbcast:1 row_mask:0xf bank_mask:0xf
    v_and_b32_dpp v54, v40, v10 row_newbcast:1 row_mask:0xf bank_mask:0xf
    v_and_b32_dpp v55, v40, v11 row_newbcast:1 row_mask:0xf bank_mask:0xf
    v_mfma_f32_16x16x32_bf16 v[48:51], a[228:231], v[24:27], 0
    s_nop 0
    v_mfma_f32_16x16x32_bf16 v[44:47], a[232:235], v[52:55], v[44:47]
    v_and_b32_dpp v24, v40, v8 row_newbcast:2 row_mask:0xf bank_mask:0xf
    v_and_b32_dpp v25, v40, v9 row_newbcast:2 row_mask:0xf bank_mask:0xf
    v_and_b32_dpp v26, v40, v10 row_newbcast:2 row_mask:0xf bank_mask:0xf
    v_and_b32_dpp v27, v40, v11 row_newbcast:2 row_mask:0xf bank_mask:0xf
    v_mfma_f32_16x16x32_bf16 v[48:51], a[236:239], v[52:55], v[48:51]
    s_nop 0
    v_mfma_f32_16x16x32_bf16 v[44:47], a[240:243], v[24:27], v[44:47]
    v_and_b32_dpp v52, v40, v8 row_newbcast:3 row_mask:0xf bank_mask:0xf
    v_and_b32_dpp v53, v40, v9 row_newbcast:3 row_mask:0xf bank_mask:0xf
    v_and_b32_dpp v54, v40, v10 row_newbcast:3 row_mask:0xf bank_mask:0xf
    v_and_b32_dpp v55, v40, v11 row_newbcast:3 row_mask:0xf bank_mask:0xf
    v_mfma_f32_16x16x32_bf16 v[48:51], a[244:247], v[24:27], v[48:51]
    s_nop 0
    v_mfma_f32_16x16x32_bf16 v[44:47], a[248:251], v[52:55], v[44:47]
    v_and_b32_dpp v24, v40, v8 row_newbcast:4 row_mask:0xf bank_mask:0xf
    v_and_b32_dpp v25, v40, v9 row_newbcast:4 row_mask:0xf bank_mask:0xf
    v_and_b32_dpp v26, v40, v10 row_newbcast:4 row_mask:0xf bank_mask:0xf
    v_and_b32_dpp v27, v40, v11 row_newbcast:4 row_mask:0xf bank_mask:0xf
    v_mfma_f32_16x16x32_bf16 v[48:51], a[252:255], v[52:55], v[48:51]
    s_nop 0
    v_mfma_f32_16x16x32_bf16 v[44:47], v[64:67], v[24:27], v[44:47]
    v_and_b32_dpp v52, v40, v8 row_newbcast:5 row_mask:0xf bank_mask:0xf
    v_and_b32_dpp v53, v40, v9 row_newbcast:5 row_mask:0xf bank_mask:0xf
    v_and_b32_dpp v54, v40, v10 row_newbcast:5 row_mask:0xf bank_mask:0xf
    v_and_b32_dpp v55, v40, v11 row_newbcast:5 row_mask:0xf bank_mask:0xf
    v_mfma_f32_16x16x32_bf16 v[48:51], v[68:71], v[24:27], v[48:51]
    s_nop 0
    v_mfma_f32_16x16x32_bf16 v[44:47], v[72:75], v[52:55], v[44:47]
    v_and_b32_dpp v24, v40, v8 row_newbcast:6 row_mask:0xf bank_mask:0xf
    v_and_b32_dpp v25, v40, v9 row_newbcast:6 row_mask:0xf bank_mask:0xf
    v_and_b32_dpp v26, v40, v10 row_newbcast:6 row_mask:0xf bank_mask:0xf
    v_and_b32_dpp v27, v40, v11 row_newbcast:6 row_mask:0xf bank_mask:0xf
    v_mfma_f32_16x16x32_bf16 v[48:51], v[76:79], v[52:55], v[48:51]
    s_nop 0
    v_mfma_f32_16x16x32_bf16 v[44:47], v[80:83], v[24:27], v[44:47]
    v_and_b32_dpp v52, v40, v8 row_newbcast:7 row_mask:0xf bank_mask:0xf
    v_and_b32_dpp v53, v40, v9 row_newbcast:7 row_mask:0xf bank_mask:0xf
    v_and_b32_dpp v54, v40, v10 row_newbcast:7 row_mask:0xf bank_mask:0xf
    v_and_b32_dpp v55, v40, v11 row_newbcast:7 row_mask:0xf bank_mask:0xf
    v_mfma_f32_16x16x32_bf16 v[48:51], v[84:87], v[24:27], v[48:51]
    s_nop 0
    v_mfma_f32_16x16x32_bf16 v[44:47], v[88:91], v[52:55], v[44:47]
    v_and_b32_dpp v24, v40, v8 row_newbcast:8 row_mask:0xf bank_mask:0xf
    v_and_b32_dpp v25, v40, v9 row_newbcast:8 row_mask:0xf bank_mask:0xf
    v_and_b32_dpp v26, v40, v10 row_newbcast:8 row_mask:0xf bank_mask:0xf
    v_and_b32_dpp v27, v40, v11 row_newbcast:8 row_mask:0xf bank_mask:0xf
    v_mfma_f32_16x16x32_bf16 v[48:51], v[92:95], v[52:55], v[48:51]
    s_nop 0
    v_mfma_f32_16x16x32_bf16 v[44:47], v[96:99], v[24:27], v[44:47]
    v_and_b32_dpp v52, v40, v8 row_newbcast:9 row_mask:0xf bank_mask:0xf
    v_and_b32_dpp v53, v40, v9 row_newbcast:9 row_mask:0xf bank_mask:0xf
    v_and_b32_dpp v54, v40, v10 row_newbcast:9 row_mask:0xf bank_mask:0xf
    v_and_b32_dpp v55, v40, v11 row_newbcast:9 row_mask:0xf bank_mask:0xf
    v_mfma_f32_16x16x32_bf16 v[48:51], v[100:103], v[24:27], v[48:51]
    s_nop 0
    v_mfma_f32_16x16x32_bf16 v[44:47], v[104:107], v[52:55], v[44:47]
    v_and_b32_dpp v24, v40, v8 row_newbcast:10 row_mask:0xf bank_mask:0xf
    v_and_b32_dpp v25, v40, v9 row_newbcast:10 row_mask:0xf bank_mask:0xf
    v_and_b32_dpp v26, v40, v10 row_newbcast:10 row_mask:0xf bank_mask:0xf
    v_and_b32_dpp v27, v40, v11 row_newbcast:10 row_mask:0xf bank_mask:0xf
    v_mfma_f32_16x16x32_bf16 v[48:51], v[108:111], v[52:55], v[48:51]
    s_nop 0
    v_mfma_f32_16x16x32_bf16 v[44:47], v[112:115], v[24:27], v[44:47]
    v_and_b32_dpp v52, v40, v8 row_newbcast:11 row_mask:0xf bank_mask:0xf
    v_and_b32_dpp v53, v40, v9 row_newbcast:11 row_mask:0xf bank_mask:0xf
    v_and_b32_dpp v54, v40, v10 row_newbcast:11 row_mask:0xf bank_mask:0xf
    v_and_b32_dpp v55, v40, v11 row_newbcast:11 row_mask:0xf bank_mask:0xf
    v_mfma_f32_16x16x32_bf16 v[48:51], v[116:119], v[24:27], v[48:51]
    s_nop 0
    v_mfma_f32_16x16x32_bf16 v[44:47], v[120:123], v[52:55], v[44:47]
    v_and_b32_dpp v24, v40, v8 row_newbcast:12 row_mask:0xf bank_mask:0xf
    v_and_b32_dpp v25, v40, v9 row_newbcast:12 row_mask:0xf bank_mask:0xf
    v_and_b32_dpp v26, v40, v10 row_newbcast:12 row_mask:0xf bank_mask:0xf
    v_and_b32_dpp v27, v40, v11 row_newbcast:12 row_mask:0xf bank_mask:0xf
    v_mfma_f32_16x16x32_bf16 v[48:51], v[124:127], v[52:55], v[48:51]
    s_nop 0
    v_mfma_f32_16x16x32_bf16 v[44:47], v[128:131], v[24:27], v[44:47]
    v_and_b32_dpp v52, v40, v8 row_newbcast:13 row_mask:0xf bank_mask:0xf
    v_and_b32_dpp v53, v40, v9 row_newbcast:13 row_mask:0xf bank_mask:0xf
    v_and_b32_dpp v54, v40, v10 row_newbcast:13 row_mask:0xf bank_mask:0xf
    v_and_b32_dpp v55, v40, v11 row_newbcast:13 row_mask:0xf bank_mask:0xf
    v_mfma_f32_16x16x32_bf16 v[48:51], v[132:135], v[24:27], v[48:51]
    s_nop 0
    v_mfma_f32_16x16x32_bf16 v[44:47], v[136:139], v[52:55], v[44:47]
    v_and_b32_dpp v24, v40, v8 row_newbcast:14 row_mask:0xf bank_mask:0xf
    v_and_b32_dpp v25, v40, v9 row_newbcast:14 row_mask:0xf bank_mask:0xf
    v_and_b32_dpp v26, v40, v10 row_newbcast:14 row_mask:0xf bank_mask:0xf
    v_and_b32_dpp v27, v40, v11 row_newbcast:14 row_mask:0xf bank_mask:0xf
    v_mfma_f32_16x16x32_bf16 v[48:51], v[140:143], v[52:55], v[48:51]
    s_nop 0
    v_mfma_f32_16x16x32_bf16 v[44:47], v[144:147], v[24:27], v[44:47]
    v_and_b32_dpp v52, v40, v8 row_newbcast:15 row_mask:0xf bank_mask:0xf
    v_and_b32_dpp v53, v40, v9 row_newbcast:15 row_mask:0xf bank_mask:0xf
    v_and_b32_dpp v54, v40, v10 row_newbcast:15 row_mask:0xf bank_mask:0xf
    v_and_b32_dpp v55, v40, v11 row_newbcast:15 row_mask:0xf bank_mask:0xf
    v_mfma_f32_16x16x32_bf16 v[48:51], v[148:151], v[24:27], v[48:51]
    s_nop 0
    v_mfma_f32_16x16x32_bf16 v[44:47], v[152:155], v[52:55], v[44:47]
    v_and_b32_dpp v24, v41, v8 row_newbcast:0 row_mask:0xf bank_mask:0xf
    v_and_b32_dpp v25, v41, v9 row_newbcast:0 row_mask:0xf bank_mask:0xf
    v_and_b32_dpp v26, v41, v10 row_newbcast:0 row_mask:0xf bank_mask:0xf
    v_and_b32_dpp v27, v41, v11 row_newbcast:0 row_mask:0xf bank_mask:0xf
    v_mfma_f32_16x16x32_bf16 v[48:51], v[156:159], v[52:55], v[48:51]
    s_nop 0
    v_mfma_f32_16x16x32_bf16 v[44:47], v[160:163], v[24:27], v[44:47]
    v_and_b32_dpp v52, v41, v8 row_newbcast:1 row_mask:0xf bank_mask:0xf
    v_and_b32_dpp v53, v41, v9 row_newbcast:1 row_mask:0xf bank_mask:0xf
    v_and_b32_dpp v54, v41, v10 row_newbcast:1 row_mask:0xf bank_mask:0xf
    v_and_b32_dpp v55, v41, v11 row_newbcast:1 row_mask:0xf bank_mask:0xf
    v_mfma_f32_16x16x32_bf16 v[48:51], v[164:167], v[24:27], v[48:51]
    s_nop 0
    v_mfma_f32_16x16x32_bf16 v[44:47], v[168:171], v[52:55], v[44:47]
    v_and_b32_dpp v24, v41, v8 row_newbcast:2 row_mask:0xf bank_mask:0xf
    v_and_b32_dpp v25, v41, v9 row_newbcast:2 row_mask:0xf bank_mask:0xf
    v_and_b32_dpp v26, v41, v10 row_newbcast:2 row_mask:0xf bank_mask:0xf
    v_and_b32_dpp v27, v41, v11 row_newbcast:2 row_mask:0xf bank_mask:0xf
    v_mfma_f32_16x16x32_bf16 v[48:51], v[172:175], v[52:55], v[48:51]
    s_nop 0
    v_mfma_f32_16x16x32_bf16 v[44:47], v[176:179], v[24:27], v[44:47]
    v_and_b32_dpp v52, v41, v8 row_newbcast:3 row_mask:0xf bank_mask:0xf
    v_and_b32_dpp v53, v41, v9 row_newbcast:3 row_mask:0xf bank_mask:0xf
    v_and_b32_dpp v54, v41, v10 row_newbcast:3 row_mask:0xf bank_mask:0xf
    v_and_b32_dpp v55, v41, v11 row_newbcast:3 row_mask:0xf bank_mask:0xf
    v_mfma_f32_16x16x32_bf16 v[48:51], v[180:183], v[24:27], v[48:51]
    s_nop 0
    v_mfma_f32_16x16x32_bf16 v[44:47], v[184:187], v[52:55], v[44:47]
    v_and_b32_dpp v24, v41, v8 row_newbcast:4 row_mask:0xf bank_mask:0xf
    v_and_b32_dpp v25, v41, v9 row_newbcast:4 row_mask:0xf bank_mask:0xf
    v_and_b32_dpp v26, v41, v10 row_newbcast:4 row_mask:0xf bank_mask:0xf
    v_and_b32_dpp v27, v41, v11 row_newbcast:4 row_mask:0xf bank_mask:0xf
    v_mfma_f32_16x16x32_bf16 v[48:51], v[188:191], v[52:55], v[48:51]
    s_nop 0
    v_mfma_f32_16x16x32_bf16 v[44:47], v[192:195], v[24:27], v[44:47]
    v_and_b32_dpp v52, v41, v8 row_newbcast:5 row_mask:0xf bank_mask:0xf
    v_and_b32_dpp v53, v41, v9 row_newbcast:5 row_mask:0xf bank_mask:0xf
    v_and_b32_dpp v54, v41, v10 row_newbcast:5 row_mask:0xf bank_mask:0xf
    v_and_b32_dpp v55, v41, v11 row_newbcast:5 row_mask:0xf bank_mask:0xf
    v_mfma_f32_16x16x32_bf16 v[48:51], v[196:199], v[24:27], v[48:51]
    s_nop 0
    v_mfma_f32_16x16x32_bf16 v[44:47], v[200:203], v[52:55], v[44:47]
    v_and_b32_dpp v24, v41, v8 row_newbcast:6 row_mask:0xf bank_mask:0xf
    v_and_b32_dpp v25, v41, v9 row_newbcast:6 row_mask:0xf bank_mask:0xf
    v_and_b32_dpp v26, v41, v10 row_newbcast:6 row_mask:0xf bank_mask:0xf
    v_and_b32_dpp v27, v41, v11 row_newbcast:6 row_mask:0xf bank_mask:0xf
    v_mfma_f32_16x16x32_bf16 v[48:51], v[204:207], v[52:55], v[48:51]
    s_nop 0
    v_mfma_f32_16x16x32_bf16 v[44:47], v[208:211], v[24:27], v[44:47]
    v_and_b32_dpp v52, v41, v8 row_newbcast:7 row_mask:0xf bank_mask:0xf
    v_and_b32_dpp v53, v41, v9 row_newbcast:7 row_mask:0xf bank_mask:0xf
    v_and_b32_dpp v54, v41, v10 row_newbcast:7 row_mask:0xf bank_mask:0xf
    v_and_b32_dpp v55, v41, v11 row_newbcast:7 row_mask:0xf bank_mask:0xf
    v_mfma_f32_16x16x32_bf16 v[48:51], v[212:215], v[24:27], v[48:51]
    s_nop 0
    v_mfma_f32_16x16x32_bf16 v[44:47], v[216:219], v[52:55], v[44:47]
    v_and_b32_dpp v24, v41, v8 row_newbcast:8 row_mask:0xf bank_mask:0xf
    v_and_b32_dpp v25, v41, v9 row_newbcast:8 row_mask:0xf bank_mask:0xf
    v_and_b32_dpp v26, v41, v10 row_newbcast:8 row_mask:0xf bank_mask:0xf
    v_and_b32_dpp v27, v41, v11 row_newbcast:8 row_mask:0xf bank_mask:0xf
    v_mfma_f32_16x16x32_bf16 v[48:51], v[220:223], v[52:55], v[48:51]
    s_nop 0
    v_mfma_f32_16x16x32_bf16 v[44:47], v[224:227], v[24:27], v[44:47]
    v_and_b32_dpp v52, v41, v8 row_newbcast:9 row_mask:0xf bank_mask:0xf
    v_and_b32_dpp v53, v41, v9 row_newbcast:9 row_mask:0xf bank_mask:0xf
    v_and_b32_dpp v54, v41, v10 row_newbcast:9 row_mask:0xf bank_mask:0xf
    v_and_b32_dpp v55, v41, v11 row_newbcast:9 row_mask:0xf bank_mask:0xf
    v_mfma_f32_16x16x32_bf16 v[48:51], v[228:231], v[24:27], v[48:51]
    s_nop 0
    v_mfma_f32_16x16x32_bf16 v[44:47], v[232:235], v[52:55], v[44:47]
    v_and_b32_dpp v24, v41, v8 row_newbcast:10 row_mask:0xf bank_mask:0xf
    v_and_b32_dpp v25, v41, v9 row_newbcast:10 row_mask:0xf bank_mask:0xf
    v_and_b32_dpp v26, v41, v10 row_newbcast:10 row_mask:0xf bank_mask:0xf
    v_and_b32_dpp v27, v41, v11 row_newbcast:10 row_mask:0xf bank_mask:0xf
    v_mfma_f32_16x16x32_bf16 v[48:51], v[236:239], v[52:55], v[48:51]
    s_nop 0
    v_mfma_f32_16x16x32_bf16 v[44:47], v[240:243], v[24:27], v[44:47]
    v_and_b32_dpp v52, v41, v8 row_newbcast:11 row_mask:0xf bank_mask:0xf
    v_and_b32_dpp v53, v41, v9 row_newbcast:11 row_mask:0xf bank_mask:0xf
    v_and_b32_dpp v54, v41, v10 row_newbcast:11 row_mask:0xf bank_mask:0xf
    v_and_b32_dpp v55, v41, v11 row_newbcast:11 row_mask:0xf bank_mask:0xf
    v_mfma_f32_16x16x32_bf16 v[48:51], v[244:247], v[24:27], v[48:51]
    s_nop 0
    v_mfma_f32_16x16x32_bf16 v[44:47], v[248:251], v[52:55], v[44:47]
    v_mfma_f32_16x16x32_bf16 v[48:51], v[252:255], v[52:55], v[48:51]
    s_nop 7
    s_mov_b32 exec_lo, 0xff00ff
    s_mov_b32 exec_hi, 0xff00ff
    ds_write_b32 v17, v44 offset:0
    ds_write_b32 v17, v45 offset:128
    ds_write_b32 v17, v46 offset:256
    ds_write_b32 v17, v47 offset:384
    ds_write_b32 v17, v48 offset:2048
    ds_write_b32 v17, v49 offset:2176
    ds_write_b32 v17, v50 offset:2304
    ds_write_b32 v17, v51 offset:2432
    s_mov_b64 exec, -1
    s_waitcnt lgkmcnt(0)
    s_barrier
    ds_read_b128 v[28:31], v18 offset:0
    ds_read_b128 v[32:35], v18 offset:2048
    ds_read_b128 v[36:39], v18 offset:1024
    ds_read_b128 v[40:43], v18 offset:3072
    s_lshl_b32 s7, s3, 11
    v_add_u32 v44, s7, v19
    v_add_u32 v45, 57344, v44
    ds_read_b128 v[48:51], v44 offset:0
    ds_read_b128 v[52:55], v44 offset:1024
    ds_read_b128 v[56:59], v44 offset:7168
    ds_read_b128 v[60:63], v44 offset:8192
    s_waitcnt lgkmcnt(4)
    v_add_f32 v28, v28, v29
    v_add_f32 v30, v30, v31
    v_add_f32 v32, v32, v33
    v_add_f32 v34, v34, v35
    v_add_f32 v36, v36, v37
    v_add_f32 v38, v38, v39
    v_add_f32 v40, v40, v41
    v_add_f32 v42, v42, v43
    v_add_f32 v28, v28, v30
    v_add_f32 v32, v32, v34
    v_add_f32 v36, v36, v38
    v_add_f32 v40, v40, v42
    v_cvt_pk_bf16_f32 v28, v28, v28
    v_and_b32 v28, 0xffff0000, v28
    v_cvt_pk_bf16_f32 v32, v32, v32
    v_and_b32 v32, 0xffff0000, v32
    v_cvt_pk_bf16_f32 v36, v36, v36
    v_and_b32 v36, 0xffff0000, v36
    v_cvt_pk_bf16_f32 v40, v40, v40
    v_and_b32 v40, 0xffff0000, v40
    v_mul_f32 v28, 0xbfb8aa3b, v28
    v_mul_f32 v36, 0xbfb8aa3b, v36
    v_exp_f32 v28, v28
    v_exp_f32 v36, v36
    s_nop 0
    v_add_f32 v28, 1.0, v28
    v_add_f32 v36, 1.0, v36
    v_rcp_f32 v28, v28
    v_rcp_f32 v36, v36
    s_nop 0
    v_cvt_pk_bf16_f32 v28, v28, v28
    v_and_b32 v28, 0xffff0000, v28
    v_cvt_pk_bf16_f32 v36, v36, v36
    v_and_b32 v36, 0xffff0000, v36
    v_mul_f32 v28, v28, v32
    v_mul_f32 v36, v36, v40
    v_cvt_pk_bf16_f32 v29, v28, v28
    v_cvt_pk_bf16_f32 v30, v36, v36
    s_nop 1
    v_mov_b32_dpp v31, v29 row_newbcast:0 row_mask:0xf bank_mask:0xf
    v_mov_b32_dpp v28, v29 row_newbcast:8 row_mask:0xf bank_mask:0xf
    v_cndmask_b32 v31, v31, v28, s[12:13]
    v_and_b32 v24, v31, v4
    v_and_b32 v25, v31, v5
    v_and_b32 v26, v31, v6
    v_and_b32 v27, v31, v7
    s_nop 0
    s_waitcnt lgkmcnt(3)
    v_mfma_f32_16x16x32_bf16 v[32:35], v[48:51], v[24:27], 0
    ds_read_b128 v[48:51], v44 offset:14336
    v_mov_b32_dpp v31, v29 row_newbcast:1 row_mask:0xf bank_mask:0xf
    v_mov_b32_dpp v28, v29 row_newbcast:9 row_mask:0xf bank_mask:0xf
    v_cndmask_b32 v31, v31, v28, s[12:13]
    v_and_b32 v40, v31, v4
    v_and_b32 v41, v31, v5
    v_and_b32 v42, v31, v6
    v_and_b32 v43, v31, v7
    s_waitcnt lgkmcnt(3)
    v_mfma_f32_16x16x32_bf16 v[36:39], v[52:55], v[24:27], 0
    ds_read_b128 v[52:55], v44 offset:15360
    s_waitcnt lgkmcnt(3)
    v_mfma_f32_16x16x32_bf16 v[32:35], v[56:59], v[40:43], v[32:35]
    ds_read_b128 v[56:59], v44 offset:21504
    v_mov_b32_dpp v31, v29 row_newbcast:2 row_mask:0xf bank_mask:0xf
    v_mov_b32_dpp v28, v29 row_newbcast:10 row_mask:0xf bank_mask:0xf
    v_cndmask_b32 v31, v31, v28, s[12:13]
    v_and_b32 v24, v31, v4
    v_and_b32 v25, v31, v5
    v_and_b32 v26, v31, v6
    v_and_b32 v27, v31, v7
    s_waitcnt lgkmcnt(3)
    v_mfma_f32_16x16x32_bf16 v[36:39], v[60:63], v[40:43], v[36:39]
    ds_read_b128 v[60:63], v44 offset:22528
    s_waitcnt lgkmcnt(3)
    v_mfma_f32_16x16x32_bf16 v[32:35], v[48:51], v[24:27], v[32:35]
    ds_read_b128 v[48:51], v44 offset:28672
    v_mov_b32_dpp v31, v29 row_newbcast:3 row_mask:0xf bank_mask:0xf
    v_mov_b32_dpp v28, v29 row_newbcast:11 row_mask:0xf bank_mask:0xf
    v_cndmask_b32 v31, v31, v28, s[12:13]
    v_and_b32 v40, v31, v4
    v_and_b32 v41, v31, v5
    v_and_b32 v42, v31, v6
    v_and_b32 v43, v31, v7
    s_waitcnt lgkmcnt(3)
    v_mfma_f32_16x16x32_bf16 v[36:39], v[52:55], v[24:27], v[36:39]
    ds_read_b128 v[52:55], v44 offset:29696
    s_waitcnt lgkmcnt(3)
    v_mfma_f32_16x16x32_bf16 v[32:35], v[56:59], v[40:43], v[32:35]
    ds_read_b128 v[56:59], v44 offset:35840
    v_mov_b32_dpp v31, v29 row_newbcast:4 row_mask:0xf bank_mask:0xf
    v_mov_b32_dpp v28, v29 row_newbcast:12 row_mask:0xf bank_mask:0xf
    v_cndmask_b32 v31, v31, v28, s[12:13]
    v_and_b32 v24, v31, v4
    v_and_b32 v25, v31, v5
    v_and_b32 v26, v31, v6
    v_and_b32 v27, v31, v7
    s_waitcnt lgkmcnt(3)
    v_mfma_f32_16x16x32_bf16 v[36:39], v[60:63], v[40:43], v[36:39]
    ds_read_b128 v[60:63], v44 offset:36864
    s_waitcnt lgkmcnt(3)
    v_mfma_f32_16x16x32_bf16 v[32:35], v[48:51], v[24:27], v[32:35]
    ds_read_b128 v[48:51], v44 offset:43008
    v_mov_b32_dpp v31, v29 row_newbcast:5 row_mask:0xf bank_mask:0xf
    v_mov_b32_dpp v28, v29 row_newbcast:13 row_mask:0xf bank_mask:0xf
    v_cndmask_b32 v31, v31, v28, s[12:13]
    v_and_b32 v40, v31, v4
    v_and_b32 v41, v31, v5
    v_and_b32 v42, v31, v6
    v_and_b32 v43, v31, v7
    s_waitcnt lgkmcnt(3)
    v_mfma_f32_16x16x32_bf16 v[36:39], v[52:55], v[24:27], v[36:39]
    ds_read_b128 v[52:55], v44 offset:44032
    s_waitcnt lgkmcnt(3)
    v_mfma_f32_16x16x32_bf16 v[32:35], v[56:59], v[40:43], v[32:35]
    ds_read_b128 v[56:59], v44 offset:50176
    v_mov_b32_dpp v31, v29 row_newbcast:6 row_mask:0xf bank_mask:0xf
    v_mov_b32_dpp v28, v29 row_newbcast:14 row_mask:0xf bank_mask:0xf
    v_cndmask_b32 v31, v31, v28, s[12:13]
    v_and_b32 v24, v31, v4
    v_and_b32 v25, v31, v5
    v_and_b32 v26, v31, v6
    v_and_b32 v27, v31, v7
    s_waitcnt lgkmcnt(3)
    v_mfma_f32_16x16x32_bf16 v[36:39], v[60:63], v[40:43], v[36:39]
    ds_read_b128 v[60:63], v44 offset:51200
    s_waitcnt lgkmcnt(3)
    v_mfma_f32_16x16x32_bf16 v[32:35], v[48:51], v[24:27], v[32:35]
    ds_read_b128 v[48:51], v45 offset:0
    v_mov_b32_dpp v31, v29 row_newbcast:7 row_mask:0xf bank_mask:0xf
    v_mov_b32_dpp v28, v29 row_newbcast:15 row_mask:0xf bank_mask:0xf
    v_cndmask_b32 v31, v31, v28, s[12:13]
    v_and_b32 v40, v31, v4
    v_and_b32 v41, v31, v5
    v_and_b32 v42, v31, v6
    v_and_b32 v43, v31, v7
    s_waitcnt lgkmcnt(3)
    v_mfma_f32_16x16x32_bf16 v[36:39], v[52:55], v[24:27], v[36:39]
    ds_read_b128 v[52:55], v45 offset:1024
    s_waitcnt lgkmcnt(3)
    v_mfma_f32_16x16x32_bf16 v[32:35], v[56:59], v[40:43], v[32:35]
    ds_read_b128 v[56:59], v45 offset:7168
    v_mov_b32_dpp v31, v30 row_newbcast:0 row_mask:0xf bank_mask:0xf
    v_mov_b32_dpp v28, v30 row_newbcast:8 row_mask:0xf bank_mask:0xf
    v_cndmask_b32 v31, v31, v28, s[12:13]
    v_and_b32 v24, v31, v4
    v_and_b32 v25, v31, v5
    v_and_b32 v26, v31, v6
    v_and_b32 v27, v31, v7
    s_waitcnt lgkmcnt(3)
    v_mfma_f32_16x16x32_bf16 v[36:39], v[60:63], v[40:43], v[36:39]
    ds_read_b128 v[60:63], v45 offset:8192
    s_waitcnt lgkmcnt(3)
    v_mfma_f32_16x16x32_bf16 v[32:35], v[48:51], v[24:27], v[32:35]
    ds_read_b128 v[48:51], v45 offset:14336
    v_mov_b32_dpp v31, v30 row_newbcast:1 row_mask:0xf bank_mask:0xf
    v_mov_b32_dpp v28, v30 row_newbcast:9 row_mask:0xf bank_mask:0xf
    v_cndmask_b32 v31, v31, v28, s[12:13]
    v_and_b32 v40, v31, v4
    v_and_b32 v41, v31, v5
    v_and_b32 v42, v31, v6
    v_and_b32 v43, v31, v7
    s_waitcnt lgkmcnt(3)
    v_mfma_f32_16x16x32_bf16 v[36:39], v[52:55], v[24:27], v[36:39]
    ds_read_b128 v[52:55], v45 offset:15360
    s_waitcnt lgkmcnt(3)
    v_mfma_f32_16x16x32_bf16 v[32:35], v[56:59], v[40:43], v[32:35]
    ds_read_b128 v[56:59], v45 offset:21504
    v_mov_b32_dpp v31, v30 row_newbcast:2 row_mask:0xf bank_mask:0xf
    v_mov_b32_dpp v28, v30 row_newbcast:10 row_mask:0xf bank_mask:0xf
    v_cndmask_b32 v31, v31, v28, s[12:13]
    v_and_b32 v24, v31, v4
    v_and_b32 v25, v31, v5
    v_and_b32 v26, v31, v6
    v_and_b32 v27, v31, v7
    s_waitcnt lgkmcnt(3)
    v_mfma_f32_16x16x32_bf16 v[36:39], v[60:63], v[40:43], v[36:39]
    ds_read_b128 v[60:63], v45 offset:22528
    s_waitcnt lgkmcnt(3)
    v_mfma_f32_16x16x32_bf16 v[32:35], v[48:51], v[24:27], v[32:35]
    ds_read_b128 v[48:51], v45 offset:28672
    v_mov_b32_dpp v31, v30 row_newbcast:3 row_mask:0xf bank_mask:0xf
    v_mov_b32_dpp v28, v30 row_newbcast:11 row_mask:0xf bank_mask:0xf
    v_cndmask_b32 v31, v31, v28, s[12:13]
    v_and_b32 v40, v31, v4
    v_and_b32 v41, v31, v5
    v_and_b32 v42, v31, v6
    v_and_b32 v43, v31, v7
    s_waitcnt lgkmcnt(3)
    v_mfma_f32_16x16x32_bf16 v[36:39], v[52:55], v[24:27], v[36:39]
    ds_read_b128 v[52:55], v45 offset:29696
    s_waitcnt lgkmcnt(3)
    v_mfma_f32_16x16x32_bf16 v[32:35], v[56:59], v[40:43], v[32:35]
    ds_read_b128 v[56:59], v45 offset:35840
    v_mov_b32_dpp v31, v30 row_newbcast:4 row_mask:0xf bank_mask:0xf
    v_mov_b32_dpp v28, v30 row_newbcast:12 row_mask:0xf bank_mask:0xf
    v_cndmask_b32 v31, v31, v28, s[12:13]
    v_and_b32 v24, v31, v4
    v_and_b32 v25, v31, v5
    v_and_b32 v26, v31, v6
    v_and_b32 v27, v31, v7
    s_waitcnt lgkmcnt(3)
    v_mfma_f32_16x16x32_bf16 v[36:39], v[60:63], v[40:43], v[36:39]
    ds_read_b128 v[60:63], v45 offset:36864
    s_waitcnt lgkmcnt(3)
    v_mfma_f32_16x16x32_bf16 v[32:35], v[48:51], v[24:27], v[32:35]
    v_mov_b32_dpp v31, v30 row_newbcast:5 row_mask:0xf bank_mask:0xf
    v_mov_b32_dpp v28, v30 row_newbcast:13 row_mask:0xf bank_mask:0xf
    v_cndmask_b32 v31, v31, v28, s[12:13]
    v_and_b32 v40, v31, v4
    v_and_b32 v41, v31, v5
    v_and_b32 v42, v31, v6
    v_and_b32 v43, v31, v7
    s_waitcnt lgkmcnt(2)
    v_mfma_f32_16x16x32_bf16 v[36:39], v[52:55], v[24:27], v[36:39]
    s_waitcnt lgkmcnt(1)
    v_mfma_f32_16x16x32_bf16 v[32:35], v[56:59], v[40:43], v[32:35]
    s_waitcnt lgkmcnt(0)
    v_mfma_f32_16x16x32_bf16 v[36:39], v[60:63], v[40:43], v[36:39]
    s_nop 7
    v_mov_b32_dpp v40, v32 row_ror:8 row_mask:0xf bank_mask:0xf
    v_mov_b32_dpp v41, v33 row_ror:8 row_mask:0xf bank_mask:0xf
    v_mov_b32_dpp v42, v34 row_ror:8 row_mask:0xf bank_mask:0xf
    v_mov_b32_dpp v43, v35 row_ror:8 row_mask:0xf bank_mask:0xf
    v_mov_b32_dpp v44, v36 row_ror:8 row_mask:0xf bank_mask:0xf
    v_mov_b32_dpp v45, v37 row_ror:8 row_mask:0xf bank_mask:0xf
    v_mov_b32_dpp v46, v38 row_ror:8 row_mask:0xf bank_mask:0xf
    v_mov_b32_dpp v47, v39 row_ror:8 row_mask:0xf bank_mask:0xf
    s_nop 0
    v_permlane32_swap_b32 v40, v48
    v_permlane32_swap_b32 v41, v49
    v_permlane32_swap_b32 v42, v50
    v_permlane32_swap_b32 v43, v51
    v_permlane32_swap_b32 v44, v52
    v_permlane32_swap_b32 v45, v53
    v_permlane32_swap_b32 v46, v54
    v_permlane32_swap_b32 v47, v55
    s_nop 0
    v_add_f32 v32, v32, v48
    v_add_f32 v33, v33, v49
    v_add_f32 v34, v34, v50
    v_add_f32 v35, v35, v51
    v_add_f32 v36, v36, v52
    v_add_f32 v37, v37, v53
    v_add_f32 v38, v38, v54
    v_add_f32 v39, v39, v55
    v_min_u32 v32, -2, v32
    v_min_u32 v33, -2, v33
    v_min_u32 v34, -2, v34
    v_min_u32 v35, -2, v35
    v_min_u32 v36, -2, v36
    v_min_u32 v37, -2, v37
    v_min_u32 v38, -2, v38
    v_min_u32 v39, -2, v39
    s_sub_u32 s8, s4, 2
    s_mul_i32 s8, s8, 1792
    s_add_u32 s8, s8, s6
    s_add_u32 s8, s8, 9472
    s_cmp_eq_u32 s3, 3
    s_cselect_b32 s9, 0x80000000, s8
    s_mov_b32 exec_lo, 0xff00ff
    s_mov_b32 exec_hi, 0x0
    buffer_store_dwordx4 v[32:35], v20, s[48:51], s8 offen sc1
    buffer_store_dwordx4 v[36:39], v20, s[48:51], s9 offen offset:256 sc1
    s_mov_b64 exec, -1
    s_cmp_ge_u32 s4, 4
    s_cbranch_scc1 L_NOWQa
    s_mul_i32 s10, s3, 917504
    s_lshl_b32 s7, s2, 9
    s_add_u32 s10, s10, s7
    s_add_u32 s7, s10, 0
    buffer_load_dwordx4 a[224:227], v3, s[44:47], s7 offen
    s_add_u32 s7, s10, 256
    buffer_load_dwordx4 a[228:231], v3, s[44:47], s7 offen
    s_add_u32 s7, s10, 32768
    buffer_load_dwordx4 a[232:235], v3, s[44:47], s7 offen
    s_add_u32 s7, s10, 33024
    buffer_load_dwordx4 a[236:239], v3, s[44:47], s7 offen
    s_add_u32 s7, s10, 65536
    buffer_load_dwordx4 a[240:243], v3, s[44:47], s7 offen
    s_add_u32 s7, s10, 65792
    buffer_load_dwordx4 a[244:247], v3, s[44:47], s7 offen
    s_add_u32 s7, s10, 98304
    buffer_load_dwordx4 a[248:251], v3, s[44:47], s7 offen
    s_add_u32 s7, s10, 98560
    buffer_load_dwordx4 a[252:255], v3, s[44:47], s7 offen
    s_add_u32 s7, s10, 131072
    buffer_load_dwordx4 v[64:67], v3, s[44:47], s7 offen
    s_add_u32 s7, s10, 131328
    buffer_load_dwordx4 v[68:71], v3, s[44:47], s7 offen
    s_add_u32 s7, s10, 163840
    buffer_load_dwordx4 v[72:75], v3, s[44:47], s7 offen
    s_add_u32 s7, s10, 164096
    buffer_load_dwordx4 v[76:79], v3, s[44:47], s7 offen
    s_add_u32 s7, s10, 196608
    buffer_load_dwordx4 v[80:83], v3, s[44:47], s7 offen
    s_add_u32 s7, s10, 196864
    buffer_load_dwordx4 v[84:87], v3, s[44:47], s7 offen
    s_add_u32 s7, s10, 229376
    buffer_load_dwordx4 v[88:91], v3, s[44:47], s7 offen
    s_add_u32 s7, s10, 229632
    buffer_load_dwordx4 v[92:95], v3, s[44:47], s7 offen
    s_add_u32 s7, s10, 262144
    buffer_load_dwordx4 v[96:99], v3, s[44:47], s7 offen
    s_add_u32 s7, s10, 262400
    buffer_load_dwordx4 v[100:103], v3, s[44:47], s7 offen
    s_add_u32 s7, s10, 294912
    buffer_load_dwordx4 v[104:107], v3, s[44:47], s7 offen
    s_add_u32 s7, s10, 295168
    buffer_load_dwordx4 v[108:111], v3, s[44:47], s7 offen
    s_add_u32 s7, s10, 327680
    buffer_load_dwordx4 v[112:115], v3, s[44:47], s7 offen
    s_add_u32 s7, s10, 327936
    buffer_load_dwordx4 v[116:119], v3, s[44:47], s7 offen
    s_add_u32 s7, s10, 360448
    buffer_load_dwordx4 v[120:123], v3, s[44:47], s7 offen
    s_add_u32 s7, s10, 360704
    buffer_load_dwordx4 v[124:127], v3, s[44:47], s7 offen
    s_add_u32 s7, s10, 393216
    buffer_load_dwordx4 v[128:131], v3, s[44:47], s7 offen
    s_add_u32 s7, s10, 393472
    buffer_load_dwordx4 v[132:135], v3, s[44:47], s7 offen
    s_add_u32 s7, s10, 425984
    buffer_load_dwordx4 v[136:139], v3, s[44:47], s7 offen
    s_add_u32 s7, s10, 426240
    buffer_load_dwordx4 v[140:143], v3, s[44:47], s7 offen
    s_add_u32 s7, s10, 458752
    buffer_load_dwordx4 v[144:147], v3, s[44:47], s7 offen
    s_add_u32 s7, s10, 459008
    buffer_load_dwordx4 v[148:151], v3, s[44:47], s7 offen
    s_add_u32 s7, s10, 491520
    buffer_load_dwordx4 v[152:155], v3, s[44:47], s7 offen
    s_add_u32 s7, s10, 491776
    buffer_load_dwordx4 v[156:159], v3, s[44:47], s7 offen
    s_add_u32 s7, s10, 524288
    buffer_load_dwordx4 v[160:163], v3, s[44:47], s7 offen
    s_add_u32 s7, s10, 524544
    buffer_load_dwordx4 v[164:167], v3, s[44:47], s7 offen
    s_add_u32 s7, s10, 557056
    buffer_load_dwordx4 v[168:171], v3, s[44:47], s7 offen
    s_add_u32 s7, s10, 557312
    buffer_load_dwordx4 v[172:175], v3, s[44:47], s7 offen
    s_add_u32 s7, s10, 589824
    buffer_load_dwordx4 v[176:179], v3, s[44:47], s7 offen
    s_add_u32 s7, s10, 590080
    buffer_load_dwordx4 v[180:183], v3, s[44:47], s7 offen
    s_add_u32 s7, s10, 622592
    buffer_load_dwordx4 v[184:187], v3, s[44:47], s7 offen
    s_add_u32 s7, s10, 622848
    buffer_load_dwordx4 v[188:191], v3, s[44:47], s7 offen
    s_add_u32 s7, s10, 655360
    buffer_load_dwordx4 v[192:195], v3, s[44:47], s7 offen
    s_add_u32 s7, s10, 655616
    buffer_load_dwordx4 v[196:199], v3, s[44:47], s7 offen
    s_add_u32 s7, s10, 688128
    buffer_load_dwordx4 v[200:203], v3, s[44:47], s7 offen
    s_add_u32 s7, s10, 688384
    buffer_load_dwordx4 v[204:207], v3, s[44:47], s7 offen
    s_add_u32 s7, s10, 720896
    buffer_load_dwordx4 v[208:211], v3, s[44:47], s7 offen
    s_add_u32 s7, s10, 721152
    buffer_load_dwordx4 v[212:215], v3, s[44:47], s7 offen
L_NOWQa:
    s_cmp_lt_u32 s4, 4
    s_cbranch_scc1 L_SVZ
    s_cmp_lg_u32 s2, 0
    s_cbranch_scc1 L_SVNEXT
L_SVZ:
    s_nop 1
    s_add_u32 s5, s5, 141312
    s_mov_b32 exec_lo, 0xffffffff
    s_mov_b32 exec_hi, 0xffffff
    s_sub_u32 s8, s4, 2
    s_mul_i32 s8, s8, 1792
    s_add_u32 s8, s8, 9472
    v_add_u32 v62, s5, v12
    ds_read_b64 v[60:61], v62 offset:0
L_GZ:
    s_add_u32 s7, s8, 0
    buffer_load_dwordx2 v[28:29], v12, s[48:51], s7 offen offset:0 sc1
    s_add_u32 s7, s8, 98304
    buffer_load_dwordx2 v[30:31], v12, s[48:51], s7 offen offset:0 sc1
    s_add_u32 s7, s8, 196608
    buffer_load_dwordx2 v[32:33], v12, s[48:51], s7 offen offset:0 sc1
    s_add_u32 s7, s8, 294912
    buffer_load_dwordx2 v[34:35], v12, s[48:51], s7 offen offset:0 sc1
    s_add_u32 s7, s8, 393216
    buffer_load_dwordx2 v[36:37], v12, s[48:51], s7 offen offset:0 sc1
    s_add_u32 s7, s8, 491520
    buffer_load_dwordx2 v[38:39], v12, s[48:51], s7 offen offset:0 sc1
    s_add_u32 s7, s8, 589824
    buffer_load_dwordx2 v[40:41], v12, s[48:51], s7 offen offset:0 sc1
    s_add_u32 s7, s8, 688128
    buffer_load_dwordx2 v[42:43], v12, s[48:51], s7 offen offset:0 sc1
    s_add_u32 s7, s8, 786432
    buffer_load_dwordx2 v[44:45], v12, s[48:51], s7 offen offset:0 sc1
    s_add_u32 s7, s8, 884736
    buffer_load_dwordx2 v[46:47], v12, s[48:51], s7 offen offset:0 sc1
    s_add_u32 s7, s8, 983040
    buffer_load_dwordx2 v[48:49], v12, s[48:51], s7 offen offset:0 sc1
    s_add_u32 s7, s8, 1081344
    buffer_load_dwordx2 v[50:51], v12, s[48:51], s7 offen offset:0 sc1
    s_add_u32 s7, s8, 1179648
    buffer_load_dwordx2 v[52:53], v12, s[48:51], s7 offen offset:0 sc1
    s_add_u32 s7, s8, 1277952
    buffer_load_dwordx2 v[54:55], v12, s[48:51], s7 offen offset:0 sc1
    s_add_u32 s7, s8, 1376256
    buffer_load_dwordx2 v[56:57], v12, s[48:51], s7 offen offset:0 sc1
    s_add_u32 s7, s8, 1474560
    buffer_load_dwordx2 v[58:59], v12, s[48:51], s7 offen offset:0 sc1
    s_waitcnt vmcnt(0)
    v_max_u32 v63, v28, v29
    v_max3_u32 v63, v63, v30, v31
    v_max3_u32 v63, v63, v32, v33
    v_max3_u32 v63, v63, v34, v35
    v_max3_u32 v63, v63, v36, v37
    v_max3_u32 v63, v63, v38, v39
    v_max3_u32 v63, v63, v40, v41
    v_max3_u32 v63, v63, v42, v43
    v_max3_u32 v63, v63, v44, v45
    v_max3_u32 v63, v63, v46, v47
    v_max3_u32 v63, v63, v48, v49
    v_max3_u32 v63, v63, v50, v51
    v_max3_u32 v63, v63, v52, v53
    v_max3_u32 v63, v63, v54, v55
    v_max3_u32 v63, v63, v56, v57
    v_max3_u32 v63, v63, v58, v59
    v_cmp_eq_u32 vcc, -1, v63
    s_cbranch_vccz L_GZOK
    s_sleep 2
    s_sub_u32 s96, s96, 1
    s_cmp_eq_u32 s96, 0
    s_cbranch_scc1 L_END
    s_branch L_GZ
L_GZOK:
    v_add_f32 v28, v28, v30
    v_add_f32 v29, v29, v31
    v_add_f32 v28, v28, v32
    v_add_f32 v29, v29, v33
    v_add_f32 v28, v28, v34
    v_add_f32 v29, v29, v35
    v_add_f32 v28, v28, v36
    v_add_f32 v29, v29, v37
    v_add_f32 v28, v28, v38
    v_add_f32 v29, v29, v39
    v_add_f32 v28, v28, v40
    v_add_f32 v29, v29, v41
    v_add_f32 v28, v28, v42
    v_add_f32 v29, v29, v43
    v_add_f32 v28, v28, v44
    v_add_f32 v29, v29, v45
    v_add_f32 v28, v28, v46
    v_add_f32 v29, v29, v47
    v_add_f32 v28, v28, v48
    v_add_f32 v29, v29, v49
    v_add_f32 v28, v28, v50
    v_add_f32 v29, v29, v51
    v_add_f32 v28, v28, v52
    v_add_f32 v29, v29, v53
    v_add_f32 v28, v28, v54
    v_add_f32 v29, v29, v55
    v_add_f32 v28, v28, v56
    v_add_f32 v29, v29, v57
    v_add_f32 v28, v28, v58
    v_add_f32 v29, v29, v59
    v_cvt_pk_bf16_f32 v28, v28, v28
    v_and_b32 v28, 0xffff0000, v28
    v_cvt_pk_bf16_f32 v29, v29, v29
    v_and_b32 v29, 0xffff0000, v29
    s_waitcnt lgkmcnt(0)
    v_add_f32 v28, v28, v60
    v_add_f32 v29, v29, v61
    v_cvt_pk_bf16_f32 v28, v28, v28
    v_and_b32 v28, 0xffff0000, v28
    v_cvt_pk_bf16_f32 v29, v29, v29
    v_and_b32 v29, 0xffff0000, v29
    s_sub_u32 s5, s5, 141312
    s_cmp_lt_u32 s4, 4
    s_cbranch_scc1 L_SVZ2
    s_lshr_b32 s7, s5, 1
    buffer_store_short_d16_hi v28, v23, s[80:83], s7 offen
    buffer_store_short_d16_hi v29, v23, s[80:83], s7 offen offset:16
    s_mov_b64 exec, -1
    s_branch L_SVNEXT
L_SVZ2:
    ds_write_b64 v62, v[28:29]
    s_mov_b64 exec, -1
    s_waitcnt lgkmcnt(0)
L_SVQ:
    s_barrier
    v_add_u32 v38, s5, v21
    v_add_u32 v39, s5, v16
    s_add_u32 s7, s5, 141312
    v_mov_b32 v37, s7
    ds_read_b32 v37, v37
    ds_read2st64_b32 v[28:29], v38 offset0:0 offset1:1
    ds_read2st64_b32 v[30:31], v38 offset0:2 offset1:3
    ds_read2st64_b32 v[32:33], v38 offset0:4 offset1:5
    ds_read_b32 v34, v38 offset:1536
    ds_read_b32 v40, v39
    ds_read_b32 v41, v39 offset:256
    s_waitcnt lgkmcnt(2)
    v_sub_f32 v28, v28, v37
    v_sub_f32 v29, v29, v37
    v_sub_f32 v30, v30, v37
    v_sub_f32 v31, v31, v37
    v_sub_f32 v32, v32, v37
    v_sub_f32 v33, v33, v37
    v_sub_f32 v34, v34, v37
    v_add_f32 v36, v28, v29
    v_mul_f32 v35, v28, v28
    v_fmac_f32 v35, v29, v29
    v_fmac_f32 v35, v30, v30
    v_add_f32 v36, v36, v30
    v_fmac_f32 v35, v31, v31
    v_add_f32 v36, v36, v31
    v_fmac_f32 v35, v32, v32
    v_add_f32 v36, v36, v32
    v_fmac_f32 v35, v33, v33
    v_add_f32 v36, v36, v33
    v_fmac_f32 v35, v34, v34
    v_add_f32 v36, v36, v34
    s_nop 0
    s_nop 0
    v_add_f32_dpp v36, v36, v36 quad_perm:[1,0,3,2] row_mask:0xf bank_mask:0xf
    v_add_f32_dpp v35, v35, v35 quad_perm:[1,0,3,2] row_mask:0xf bank_mask:0xf
    s_nop 0
    v_add_f32_dpp v36, v36, v36 quad_perm:[2,3,0,1] row_mask:0xf bank_mask:0xf
    v_add_f32_dpp v35, v35, v35 quad_perm:[2,3,0,1] row_mask:0xf bank_mask:0xf
    s_nop 0
    v_add_f32_dpp v36, v36, v36 row_half_mirror row_mask:0xf bank_mask:0xf
    v_add_f32_dpp v35, v35, v35 row_half_mirror row_mask:0xf bank_mask:0xf
    s_nop 0
    v_add_f32_dpp v36, v36, v36 row_mirror row_mask:0xf bank_mask:0xf
    v_add_f32_dpp v35, v35, v35 row_mirror row_mask:0xf bank_mask:0xf
    v_mov_b32 v38, v36
    v_mov_b32 v39, v35
    s_nop 0
    v_permlane16_swap_b32 v36, v38
    v_permlane16_swap_b32 v35, v39
    v_add_f32 v36, v36, v38
    v_add_f32 v35, v35, v39
    v_mov_b32 v38, v36
    v_mov_b32 v39, v35
    s_nop 0
    v_permlane32_swap_b32 v36, v38
    v_permlane32_swap_b32 v35, v39
    v_add_f32 v36, v36, v38
    v_add_f32 v35, v35, v39
    v_mul_f32 v36, 0x3b124925, v36
    v_mul_f32 v35, 0x3b124925, v35
    v_fma_f32 v35, -v36, v36, v35
    v_add_f32 v36, v36, v37
    v_max_f32 v35, 0, v35
    v_cvt_pk_bf16_f32 v36, v36, v36
    v_and_b32 v36, 0xffff0000, v36
    v_cvt_pk_bf16_f32 v35, v35, v35
    v_and_b32 v35, 0xffff0000, v35
    s_waitcnt lgkmcnt(0)
    v_add_f32 v35, 0x3727c5ac, v35
    v_sub_f32 v40, v40, v36
    v_sub_f32 v41, v41, v36
    v_cvt_pk_bf16_f32 v35, v35, v35
    v_and_b32 v35, 0xffff0000, v35
    v_sqrt_f32 v35, v35
    v_cvt_pk_bf16_f32 v40, v40, v40
    v_and_b32 v40, 0xffff0000, v40
    v_cvt_pk_bf16_f32 v41, v41, v41
    v_and_b32 v41, 0xffff0000, v41
    v_cvt_pk_bf16_f32 v35, v35, v35
    v_and_b32 v35, 0xffff0000, v35
    v_rcp_f32 v35, v35
    s_nop 0
    v_mul_f32 v40, v40, v35
    v_mul_f32 v41, v41, v35
    v_cvt_pk_bf16_f32 v40, v40, v40
    v_cvt_pk_bf16_f32 v41, v41, v41
    s_nop 0
    v_add_u32 v42, s11, v19
    v_and_b32_dpp v24, v40, v8 row_newbcast:0 row_mask:0xf bank_mask:0xf
    v_and_b32_dpp v25, v40, v9 row_newbcast:0 row_mask:0xf bank_mask:0xf
    v_and_b32_dpp v26, v40, v10 row_newbcast:0 row_mask:0xf bank_mask:0xf
    v_and_b32_dpp v27, v40, v11 row_newbcast:0 row_mask:0xf bank_mask:0xf
    s_nop 0
    ds_read_b128 v[28:31], v42 offset:0
    ds_read_b128 v[32:35], v42 offset:1024
    ds_read_b128 v[56:59], v42 offset:2048
    ds_read_b128 v[60:63], v42 offset:3072
    s_nop 0
    v_mfma_f32_16x16x32_bf16 v[44:47], a[224:227], v[24:27], 0
    v_and_b32_dpp v52, v40, v8 row_newbcast:1 row_mask:0xf bank_mask:0xf
    v_and_b32_dpp v53, v40, v9 row_newbcast:1 row_mask:0xf bank_mask:0xf
    v_and_b32_dpp v54, v40, v10 row_newbcast:1 row_mask:0xf bank_mask:0xf
    v_and_b32_dpp v55, v40, v11 row_newbcast:1 row_mask:0xf bank_mask:0xf
    v_mfma_f32_16x16x32_bf16 v[48:51], a[228:231], v[24:27], 0
    s_nop 0
    v_mfma_f32_16x16x32_bf16 v[44:47], a[232:235], v[52:55], v[44:47]
    v_and_b32_dpp v24, v40, v8 row_newbcast:2 row_mask:0xf bank_mask:0xf
    v_and_b32_dpp v25, v40, v9 row_newbcast:2 row_mask:0xf bank_mask:0xf
    v_and_b32_dpp v26, v40, v10 row_newbcast:2 row_mask:0xf bank_mask:0xf
    v_and_b32_dpp v27, v40, v11 row_newbcast:2 row_mask:0xf bank_mask:0xf
    v_mfma_f32_16x16x32_bf16 v[48:51], a[236:239], v[52:55], v[48:51]
    s_nop 0
    v_mfma_f32_16x16x32_bf16 v[44:47], a[240:243], v[24:27], v[44:47]
    v_and_b32_dpp v52, v40, v8 row_newbcast:3 row_mask:0xf bank_mask:0xf
    v_and_b32_dpp v53, v40, v9 row_newbcast:3 row_mask:0xf bank_mask:0xf
    v_and_b32_dpp v54, v40, v10 row_newbcast:3 row_mask:0xf bank_mask:0xf
    v_and_b32_dpp v55, v40, v11 row_newbcast:3 row_mask:0xf bank_mask:0xf
    v_mfma_f32_16x16x32_bf16 v[48:51], a[244:247], v[24:27], v[48:51]
    s_nop 0
    v_mfma_f32_16x16x32_bf16 v[44:47], a[248:251], v[52:55], v[44:47]
    v_and_b32_dpp v24, v40, v8 row_newbcast:4 row_mask:0xf bank_mask:0xf
    v_and_b32_dpp v25, v40, v9 row_newbcast:4 row_mask:0xf bank_mask:0xf
    v_and_b32_dpp v26, v40, v10 row_newbcast:4 row_mask:0xf bank_mask:0xf
    v_and_b32_dpp v27, v40, v11 row_newbcast:4 row_mask:0xf bank_mask:0xf
    v_mfma_f32_16x16x32_bf16 v[48:51], a[252:255], v[52:55], v[48:51]
    s_nop 0
    v_mfma_f32_16x16x32_bf16 v[44:47], v[64:67], v[24:27], v[44:47]
    v_and_b32_dpp v52, v40, v8 row_newbcast:5 row_mask:0xf bank_mask:0xf
    v_and_b32_dpp v53, v40, v9 row_newbcast:5 row_mask:0xf bank_mask:0xf
    v_and_b32_dpp v54, v40, v10 row_newbcast:5 row_mask:0xf bank_mask:0xf
    v_and_b32_dpp v55, v40, v11 row_newbcast:5 row_mask:0xf bank_mask:0xf
    v_mfma_f32_16x16x32_bf16 v[48:51], v[68:71], v[24:27], v[48:51]
    s_nop 0
    v_mfma_f32_16x16x32_bf16 v[44:47], v[72:75], v[52:55], v[44:47]
    v_and_b32_dpp v24, v40, v8 row_newbcast:6 row_mask:0xf bank_mask:0xf
    v_and_b32_dpp v25, v40, v9 row_newbcast:6 row_mask:0xf bank_mask:0xf
    v_and_b32_dpp v26, v40, v10 row_newbcast:6 row_mask:0xf bank_mask:0xf
    v_and_b32_dpp v27, v40, v11 row_newbcast:6 row_mask:0xf bank_mask:0xf
    v_mfma_f32_16x16x32_bf16 v[48:51], v[76:79], v[52:55], v[48:51]
    s_nop 0
    v_mfma_f32_16x16x32_bf16 v[44:47], v[80:83], v[24:27], v[44:47]
    v_and_b32_dpp v52, v40, v8 row_newbcast:7 row_mask:0xf bank_mask:0xf
    v_and_b32_dpp v53, v40, v9 row_newbcast:7 row_mask:0xf bank_mask:0xf
    v_and_b32_dpp v54, v40, v10 row_newbcast:7 row_mask:0xf bank_mask:0xf
    v_and_b32_dpp v55, v40, v11 row_newbcast:7 row_mask:0xf bank_mask:0xf
    v_mfma_f32_16x16x32_bf16 v[48:51], v[84:87], v[24:27], v[48:51]
    s_nop 0
    v_mfma_f32_16x16x32_bf16 v[44:47], v[88:91], v[52:55], v[44:47]
    v_and_b32_dpp v24, v41, v8 row_newbcast:7 row_mask:0xf bank_mask:0xf
    v_and_b32_dpp v25, v41, v9 row_newbcast:7 row_mask:0xf bank_mask:0xf
    v_and_b32_dpp v26, v41, v10 row_newbcast:7 row_mask:0xf bank_mask:0xf
    v_and_b32_dpp v27, v41, v11 row_newbcast:7 row_mask:0xf bank_mask:0xf
    v_mfma_f32_16x16x32_bf16 v[48:51], v[92:95], v[52:55], v[48:51]
    s_waitcnt lgkmcnt(0)
    s_nop 0
    v_mfma_f32_16x16x32_bf16 v[44:47], v[28:31], v[24:27], v[44:47]
    v_and_b32_dpp v52, v41, v8 row_newbcast:8 row_mask:0xf bank_mask:0xf
    v_and_b32_dpp v53, v41, v9 row_newbcast:8 row_mask:0xf bank_mask:0xf
    v_and_b32_dpp v54, v41, v10 row_newbcast:8 row_mask:0xf bank_mask:0xf
    v_and_b32_dpp v55, v41, v11 row_newbcast:8 row_mask:0xf bank_mask:0xf
    v_mfma_f32_16x16x32_bf16 v[48:51], v[32:35], v[24:27], v[48:51]
    s_nop 0
    v_mfma_f32_16x16x32_bf16 v[44:47], v[56:59], v[52:55], v[44:47]
    v_and_b32_dpp v24, v40, v8 row_newbcast:8 row_mask:0xf bank_mask:0xf
    v_and_b32_dpp v25, v40, v9 row_newbcast:8 row_mask:0xf bank_mask:0xf
    v_and_b32_dpp v26, v40, v10 row_newbcast:8 row_mask:0xf bank_mask:0xf
    v_and_b32_dpp v27, v40, v11 row_newbcast:8 row_mask:0xf bank_mask:0xf
    v_mfma_f32_16x16x32_bf16 v[48:51], v[60:63], v[52:55], v[48:51]
    s_nop 0
    v_mfma_f32_16x16x32_bf16 v[44:47], v[96:99], v[24:27], v[44:47]
    v_and_b32_dpp v52, v40, v8 row_newbcast:9 row_mask:0xf bank_mask:0xf
    v_and_b32_dpp v53, v40, v9 row_newbcast:9 row_mask:0xf bank_mask:0xf
    v_and_b32_dpp v54, v40, v10 row_newbcast:9 row_mask:0xf bank_mask:0xf
    v_and_b32_dpp v55, v40, v11 row_newbcast:9 row_mask:0xf bank_mask:0xf
    v_mfma_f32_16x16x32_bf16 v[48:51], v[100:103], v[24:27], v[48:51]
    ds_read_b128 v[28:31], v42 offset:4096
    ds_read_b128 v[32:35], v42 offset:5120
    ds_read_b128 v[56:59], v42 offset:6144
    ds_read_b128 v[60:63], v42 offset:7168
    s_nop 0
    v_mfma_f32_16x16x32_bf16 v[44:47], v[104:107], v[52:55], v[44:47]
    v_and_b32_dpp v24, v40, v8 row_newbcast:10 row_mask:0xf bank_mask:0xf
    v_and_b32_dpp v25, v40, v9 row_newbcast:10 row_mask:0xf bank_mask:0xf
    v_and_b32_dpp v26, v40, v10 row_newbcast:10 row_mask:0xf bank_mask:0xf
    v_and_b32_dpp v27, v40, v11 row_newbcast:10 row_mask:0xf bank_mask:0xf
    v_mfma_f32_16x16x32_bf16 v[48:51], v[108:111], v[52:55], v[48:51]
    s_nop 0
    v_mfma_f32_16x16x32_bf16 v[44:47], v[112:115], v[24:27], v[44:47]
    v_and_b32_dpp v52, v40, v8 row_newbcast:11 row_mask:0xf bank_mask:0xf
    v_and_b32_dpp v53, v40, v9 row_newbcast:11 row_mask:0xf bank_mask:0xf
    v_and_b32_dpp v54, v40, v10 row_newbcast:11 row_mask:0xf bank_mask:0xf
    v_and_b32_dpp v55, v40, v11 row_newbcast:11 row_mask:0xf bank_mask:0xf
    v_mfma_f32_16x16x32_bf16 v[48:51], v[116:119], v[24:27], v[48:51]
    s_nop 0
    v_mfma_f32_16x16x32_bf16 v[44:47], v[120:123], v[52:55], v[44:47]
    v_and_b32_dpp v24, v40, v8 row_newbcast:12 row_mask:0xf bank_mask:0xf
    v_and_b32_dpp v25, v40, v9 row_newbcast:12 row_mask:0xf bank_mask:0xf
    v_and_b32_dpp v26, v40, v10 row_newbcast:12 row_mask:0xf bank_mask:0xf
    v_and_b32_dpp v27, v40, v11 row_newbcast:12 row_mask:0xf bank_mask:0xf
    v_mfma_f32_16x16x32_bf16 v[48:51], v[124:127], v[52:55], v[48:51]
    s_nop 0
    v_mfma_f32_16x16x32_bf16 v[44:47], v[128:131], v[24:27], v[44:47]
    v_and_b32_dpp v52, v40, v8 row_newbcast:13 row_mask:0xf bank_mask:0xf
    v_and_b32_dpp v53, v40, v9 row_newbcast:13 row_mask:0xf bank_mask:0xf
    v_and_b32_dpp v54, v40, v10 row_newbcast:13 row_mask:0xf bank_mask:0xf
    v_and_b32_dpp v55, v40, v11 row_newbcast:13 row_mask:0xf bank_mask:0xf
    v_mfma_f32_16x16x32_bf16 v[48:51], v[132:135], v[24:27], v[48:51]
    s_nop 0
    v_mfma_f32_16x16x32_bf16 v[44:47], v[136:139], v[52:55], v[44:47]
    v_and_b32_dpp v24, v40, v8 row_newbcast:14 row_mask:0xf bank_mask:0xf
    v_and_b32_dpp v25, v40, v9 row_newbcast:14 row_mask:0xf bank_mask:0xf
    v_and_b32_dpp v26, v40, v10 row_newbcast:14 row_mask:0xf bank_mask:0xf
    v_and_b32_dpp v27, v40, v11 row_newbcast:14 row_mask:0xf bank_mask:0xf
    v_mfma_f32_16x16x32_bf16 v[48:51], v[140:143], v[52:55], v[48:51]
    s_nop 0
    v_mfma_f32_16x16x32_bf16 v[44:47], v[144:147], v[24:27], v[44:47]
    v_and_b32_dpp v52, v40, v8 row_newbcast:15 row_mask:0xf bank_mask:0xf
    v_and_b32_dpp v53, v40, v9 row_newbcast:15 row_mask:0xf bank_mask:0xf
    v_and_b32_dpp v54, v40, v10 row_newbcast:15 row_mask:0xf bank_mask:0xf
    v_and_b32_dpp v55, v40, v11 row_newbcast:15 row_mask:0xf bank_mask:0xf
    v_mfma_f32_16x16x32_bf16 v[48:51], v[148:151], v[24:27], v[48:51]
    s_nop 0
    v_mfma_f32_16x16x32_bf16 v[44:47], v[152:155], v[52:55], v[44:47]
    v_and_b32_dpp v24, v41, v8 row_newbcast:9 row_mask:0xf bank_mask:0xf
    v_and_b32_dpp v25, v41, v9 row_newbcast:9 row_mask:0xf bank_mask:0xf
    v_and_b32_dpp v26, v41, v10 row_newbcast:9 row_mask:0xf bank_mask:0xf
    v_and_b32_dpp v27, v41, v11 row_newbcast:9 row_mask:0xf bank_mask:0xf
    v_mfma_f32_16x16x32_bf16 v[48:51], v[156:159], v[52:55], v[48:51]
    s_waitcnt lgkmcnt(0)
    s_nop 0
    v_mfma_f32_16x16x32_bf16 v[44:47], v[28:31], v[24:27], v[44:47]
    v_and_b32_dpp v52, v41, v8 row_newbcast:10 row_mask:0xf bank_mask:0xf
    v_and_b32_dpp v53, v41, v9 row_newbcast:10 row_mask:0xf bank_mask:0xf
    v_and_b32_dpp v54, v41, v10 row_newbcast:10 row_mask:0xf bank_mask:0xf
    v_and_b32_dpp v55, v41, v11 row_newbcast:10 row_mask:0xf bank_mask:0xf
    v_mfma_f32_16x16x32_bf16 v[48:51], v[32:35], v[24:27], v[48:51]
    s_nop 0
    v_mfma_f32_16x16x32_bf16 v[44:47], v[56:59], v[52:55], v[44:47]
    v_and_b32_dpp v24, v41, v8 row_newbcast:0 row_mask:0xf bank_mask:0xf
    v_and_b32_dpp v25, v41, v9 row_newbcast:0 row_mask:0xf bank_mask:0xf
    v_and_b32_dpp v26, v41, v10 row_newbcast:0 row_mask:0xf bank_mask:0xf
    v_and_b32_dpp v27, v41, v11 row_newbcast:0 row_mask:0xf bank_mask:0xf
    v_mfma_f32_16x16x32_bf16 v[48:51], v[60:63], v[52:55], v[48:51]
    s_nop 0
    v_mfma_f32_16x16x32_bf16 v[44:47], v[160:163], v[24:27], v[44:47]
    v_and_b32_dpp v52, v41, v8 row_newbcast:1 row_mask:0xf bank_mask:0xf
    v_and_b32_dpp v53, v41, v9 row_newbcast:1 row_mask:0xf bank_mask:0xf
    v_and_b32_dpp v54, v41, v10 row_newbcast:1 row_mask:0xf bank_mask:0xf
    v_and_b32_dpp v55, v41, v11 row_newbcast:1 row_mask:0xf bank_mask:0xf
    v_mfma_f32_16x16x32_bf16 v[48:51], v[164:167], v[24:27], v[48:51]
    ds_read_b128 v[28:31], v42 offset:8192
    ds_read_b128 v[32:35], v42 offset:9216
    s_nop 0
    v_mfma_f32_16x16x32_bf16 v[44:47], v[168:171], v[52:55], v[44:47]
    v_and_b32_dpp v24, v41, v8 row_newbcast:2 row_mask:0xf bank_mask:0xf
    v_and_b32_dpp v25, v41, v9 row_newbcast:2 row_mask:0xf bank_mask:0xf
    v_and_b32_dpp v26, v41, v10 row_newbcast:2 row_mask:0xf bank_mask:0xf
    v_and_b32_dpp v27, v41, v11 row_newbcast:2 row_mask:0xf bank_mask:0xf
    v_mfma_f32_16x16x32_bf16 v[48:51], v[172:175], v[52:55], v[48:51]
    s_nop 0
    v_mfma_f32_16x16x32_bf16 v[44:47], v[176:179], v[24:27], v[44:47]
    v_and_b32_dpp v52, v41, v8 row_newbcast:3 row_mask:0xf bank_mask:0xf
    v_and_b32_dpp v53, v41, v9 row_newbcast:3 row_mask:0xf bank_mask:0xf
    v_and_b32_dpp v54, v41, v10 row_newbcast:3 row_mask:0xf bank_mask:0xf
    v_and_b32_dpp v55, v41, v11 row_newbcast:3 row_mask:0xf bank_mask:0xf
    v_mfma_f32_16x16x32_bf16 v[48:51], v[180:183], v[24:27], v[48:51]
    s_nop 0
    v_mfma_f32_16x16x32_bf16 v[44:47], v[184:187], v[52:55], v[44:47]
    v_and_b32_dpp v24, v41, v8 row_newbcast:4 row_mask:0xf bank_mask:0xf
    v_and_b32_dpp v25, v41, v9 row_newbcast:4 row_mask:0xf bank_mask:0xf
    v_and_b32_dpp v26, v41, v10 row_newbcast:4 row_mask:0xf bank_mask:0xf
    v_and_b32_dpp v27, v41, v11 row_newbcast:4 row_mask:0xf bank_mask:0xf
    v_mfma_f32_16x16x32_bf16 v[48:51], v[188:191], v[52:55], v[48:51]
    s_nop 0
    v_mfma_f32_16x16x32_bf16 v[44:47], v[192:195], v[24:27], v[44:47]
    v_and_b32_dpp v52, v41, v8 row_newbcast:5 row_mask:0xf bank_mask:0xf
    v_and_b32_dpp v53, v41, v9 row_newbcast:5 row_mask:0xf bank_mask:0xf
    v_and_b32_dpp v54, v41, v10 row_newbcast:5 row_mask:0xf bank_mask:0xf
    v_and_b32_dpp v55, v41, v11 row_newbcast:5 row_mask:0xf bank_mask:0xf
    v_mfma_f32_16x16x32_bf16 v[48:51], v[196:199], v[24:27], v[48:51]
    s_nop 0
    v_mfma_f32_16x16x32_bf16 v[44:47], v[200:203], v[52:55], v[44:47]
    v_and_b32_dpp v24, v41, v8 row_newbcast:6 row_mask:0xf bank_mask:0xf
    v_and_b32_dpp v25, v41, v9 row_newbcast:6 row_mask:0xf bank_mask:0xf
    v_and_b32_dpp v26, v41, v10 row_newbcast:6 row_mask:0xf bank_mask:0xf
    v_and_b32_dpp v27, v41, v11 row_newbcast:6 row_mask:0xf bank_mask:0xf
    v_mfma_f32_16x16x32_bf16 v[48:51], v[204:207], v[52:55], v[48:51]
    s_nop 0
    v_mfma_f32_16x16x32_bf16 v[44:47], v[208:211], v[24:27], v[44:47]
    v_and_b32_dpp v52, v41, v8 row_newbcast:11 row_mask:0xf bank_mask:0xf
    v_and_b32_dpp v53, v41, v9 row_newbcast:11 row_mask:0xf bank_mask:0xf
    v_and_b32_dpp v54, v41, v10 row_newbcast:11 row_mask:0xf bank_mask:0xf
    v_and_b32_dpp v55, v41, v11 row_newbcast:11 row_mask:0xf bank_mask:0xf
    v_mfma_f32_16x16x32_bf16 v[48:51], v[212:215], v[24:27], v[48:51]
    s_waitcnt lgkmcnt(0)
    s_nop 0
    v_mfma_f32_16x16x32_bf16 v[44:47], v[28:31], v[52:55], v[44:47]
    v_mfma_f32_16x16x32_bf16 v[48:51], v[32:35], v[52:55], v[48:51]
    s_nop 7
    s_mov_b32 exec_lo, 0xff00ff
    s_mov_b32 exec_hi, 0xff00ff
    ds_write_b32 v17, v44 offset:0
    ds_write_b32 v17, v45 offset:128
    ds_write_b32 v17, v46 offset:256
    ds_write_b32 v17, v47 offset:384
    ds_write_b32 v17, v48 offset:2048
    ds_write_b32 v17, v49 offset:2176
    ds_write_b32 v17, v50 offset:2304
    ds_write_b32 v17, v51 offset:2432
    s_mov_b64 exec, -1
    s_waitcnt lgkmcnt(0)
    s_barrier
    s_cmp_ge_u32 s3, 2
    s_cbranch_scc1 L_SVQDONE
    s_lshl_b32 s7, s3, 11
    s_add_u32 s7, s7, 159232
    v_lshl_add_u32 v36, v0, 5, s7
    ds_read_b128 v[28:31], v36
    ds_read_b128 v[32:35], v36 offset:16
    s_lshl_b32 s8, s4, 9
    s_add_u32 s8, s8, s6
    s_lshl_b32 s7, s3, 8
    s_add_u32 s8, s8, s7
    v_lshlrev_b32 v37, 2, v0
    s_waitcnt lgkmcnt(0)
    v_add_f32 v28, v28, v29
    v_add_f32 v30, v30, v31
    v_add_f32 v28, v28, v30
    v_add_f32 v32, v32, v33
    v_add_f32 v34, v34, v35
    v_add_f32 v32, v32, v34
    v_cvt_pk_bf16_f32 v28, v28, v32
    v_min_u32 v28, -2, v28
    buffer_store_dword v28, v37, s[48:51], s8 offen offset:256 sc1
L_SVQDONE:
    s_mul_i32 s8, s3, 401408
    s_mul_i32 s7, s2, 224
    s_add_u32 s8, s8, s7
    s_add_u32 s7, s8, 0
    buffer_load_dwordx4 a[224:227], v2, s[60:63], s7 offen
    buffer_load_dwordx4 a[228:231], v2, s[64:67], s7 offen
    s_add_u32 s7, s8, 14336
    buffer_load_dwordx4 a[232:235], v2, s[60:63], s7 offen
    buffer_load_dwordx4 a[236:239], v2, s[64:67], s7 offen
    s_add_u32 s7, s8, 28672
    buffer_load_dwordx4 a[240:243], v2, s[60:63], s7 offen
    buffer_load_dwordx4 a[244:247], v2, s[64:67], s7 offen
    s_add_u32 s7, s8, 43008
    buffer_load_dwordx4 a[248:251], v2, s[60:63], s7 offen
    buffer_load_dwordx4 a[252:255], v2, s[64:67], s7 offen
    s_add_u32 s7, s8, 57344
    buffer_load_dwordx4 v[64:67], v2, s[60:63], s7 offen
    buffer_load_dwordx4 v[68:71], v2, s[64:67], s7 offen
    s_add_u32 s7, s8, 71680
    buffer_load_dwordx4 v[72:75], v2, s[60:63], s7 offen
    buffer_load_dwordx4 v[76:79], v2, s[64:67], s7 offen
    s_add_u32 s7, s8, 86016
    buffer_load_dwordx4 v[80:83], v2, s[60:63], s7 offen
    buffer_load_dwordx4 v[84:87], v2, s[64:67], s7 offen
    s_add_u32 s7, s8, 100352
    buffer_load_dwordx4 v[88:91], v2, s[60:63], s7 offen
    buffer_load_dwordx4 v[92:95], v2, s[64:67], s7 offen
    s_add_u32 s7, s8, 114688
    buffer_load_dwordx4 v[96:99], v2, s[60:63], s7 offen
    buffer_load_dwordx4 v[100:103], v2, s[64:67], s7 offen
    s_add_u32 s7, s8, 129024
    buffer_load_dwordx4 v[104:107], v2, s[60:63], s7 offen
    buffer_load_dwordx4 v[108:111], v2, s[64:67], s7 offen
    s_add_u32 s7, s8, 143360
    buffer_load_dwordx4 v[112:115], v2, s[60:63], s7 offen
    buffer_load_dwordx4 v[116:119], v2, s[64:67], s7 offen
    s_add_u32 s7, s8, 157696
    buffer_load_dwordx4 v[120:123], v2, s[60:63], s7 offen
    buffer_load_dwordx4 v[124:127], v2, s[64:67], s7 offen
    s_add_u32 s7, s8, 172032
    buffer_load_dwordx4 v[128:131], v2, s[60:63], s7 offen
    buffer_load_dwordx4 v[132:135], v2, s[64:67], s7 offen
    s_add_u32 s7, s8, 186368
    buffer_load_dwordx4 v[136:139], v2, s[60:63], s7 offen
    buffer_load_dwordx4 v[140:143], v2, s[64:67], s7 offen
    s_add_u32 s7, s8, 200704
    buffer_load_dwordx4 v[144:147], v2, s[60:63], s7 offen
    buffer_load_dwordx4 v[148:151], v2, s[64:67], s7 offen
    s_add_u32 s7, s8, 215040
    buffer_load_dwordx4 v[152:155], v2, s[60:63], s7 offen
    buffer_load_dwordx4 v[156:159], v2, s[64:67], s7 offen
    s_add_u32 s7, s8, 229376
    buffer_load_dwordx4 v[160:163], v2, s[60:63], s7 offen
    buffer_load_dwordx4 v[164:167], v2, s[64:67], s7 offen
    s_add_u32 s7, s8, 243712
    buffer_load_dwordx4 v[168:171], v2, s[60:63], s7 offen
    buffer_load_dwordx4 v[172:175], v2, s[64:67], s7 offen
    s_add_u32 s7, s8, 258048
    buffer_load_dwordx4 v[176:179], v2, s[60:63], s7 offen
    buffer_load_dwordx4 v[180:183], v2, s[64:67], s7 offen
    s_add_u32 s7, s8, 272384
    buffer_load_dwordx4 v[184:187], v2, s[60:63], s7 offen
    buffer_load_dwordx4 v[188:191], v2, s[64:67], s7 offen
    s_add_u32 s7, s8, 286720
    buffer_load_dwordx4 v[192:195], v2, s[60:63], s7 offen
    buffer_load_dwordx4 v[196:199], v2, s[64:67], s7 offen
    s_add_u32 s7, s8, 301056
    buffer_load_dwordx4 v[200:203], v2, s[60:63], s7 offen
    buffer_load_dwordx4 v[204:207], v2, s[64:67], s7 offen
    s_add_u32 s7, s8, 315392
    buffer_load_dwordx4 v[208:211], v2, s[60:63], s7 offen
    buffer_load_dwordx4 v[212:215], v2, s[64:67], s7 offen
L_SVNEXT:
    s_add_u32 s4, s4, 1
    s_cmp_lt_u32 s4, 6
    s_cbranch_scc1 L_SVLOOP
L_END:
    s_endpgm
.fill ((interleave_layers__mha_block_cached__glu_gated_glu__decode_kernel + 49408 - .) / 4), 4, 0xbf800000
.section .rodata,"a"
.p2align 6
.amdhsa_kernel interleave_layers__mha_block_cached__glu_gated_glu__decode_kernel
  .amdhsa_next_free_vgpr 512
  .amdhsa_next_free_sgpr 102
  .amdhsa_accum_offset 256
  .amdhsa_group_segment_fixed_size 0
  .amdhsa_kernarg_size 96
  .amdhsa_user_sgpr_count 2
  .amdhsa_user_sgpr_kernarg_segment_ptr 1
  .amdhsa_system_sgpr_workgroup_id_x 1
  .amdhsa_float_denorm_mode_32 3
.end_amdhsa_kernel
```
